```python
import torch

def _softmax(x, axis=-1):
    return torch.softmax(x, dim=axis)
def _gelu(x):
    return torch.nn.functional.gelu(x, approximate="tanh")
def _silu(x):
    return torch.nn.functional.silu(x)
def _sigmoid(x):
    return torch.sigmoid(x)
def _layernorm(x, axis=-1, eps=1e-5):
    m = x.mean(dim=axis, keepdim=True)
    v = x.var(dim=axis, keepdim=True, unbiased=False)
    return (x - m) / torch.sqrt(v + eps)
def _scatter_add(tgt, idx, src, axis=0):
    return tgt.clone().index_add_(axis, idx, src)
def _segment_sum(src, seg, n):
    out = torch.zeros((n,) + src.shape[1:], dtype=src.dtype)
    return out.index_add_(0, seg, src)
def _pad(x, pw):
    flat = tuple(v for pair in reversed(pw) for v in pair)
    return torch.nn.functional.pad(x, flat)

kernel_name = 'gated_mix__ssm_conv_s5__glu_gated_bilinear__prompt'

def setup_inputs():

    _w = (lambda a: (lambda t: t.to(torch.bfloat16) if t.is_floating_point() else t)(torch.as_tensor(a)))
    def _A_setup():
        B, S, D = 1, 2048, 640
        P = D
        Lambda_re = -0.5 * (lambda _x: torch.exp(torch.as_tensor(_x)))((lambda *s: torch.randn(*s, dtype=torch.bfloat16) * 0.2)(P))
        Lambda_im = (lambda *s: torch.randn(*s, dtype=torch.bfloat16) * 0.4)(P) * 1.0
        B_re = (lambda *s: torch.randn(*s, dtype=torch.bfloat16) * 0.2)(P, D) * (D ** -0.5)
        B_im = (lambda *s: torch.randn(*s, dtype=torch.bfloat16) * 0.2)(P, D) * (D ** -0.5)
        C_re = (lambda *s: torch.randn(*s, dtype=torch.bfloat16) * 0.2)(D, P) * (P ** -0.5)
        C_im = (lambda *s: torch.randn(*s, dtype=torch.bfloat16) * 0.2)(D, P) * (P ** -0.5)
        log_dt = (lambda *s: torch.randn(*s, dtype=torch.bfloat16) * 0.2)(P) * 0.3 - 2.0
        Dskip = (lambda *s: torch.randn(*s, dtype=torch.bfloat16) * 0.05)(D)
        return {
            "x": _w((lambda *s: torch.randn(*s, dtype=torch.bfloat16) * 0.05)(B, S, D)),
            "Lambda_re": _w(Lambda_re),
            "Lambda_im": _w(Lambda_im),
            "B_re": _w(B_re),
            "B_im": _w(B_im),
            "C_re": _w(C_re),
            "C_im": _w(C_im),
            "log_dt": _w(log_dt),
            "Dskip": _w(Dskip),
        }
    _A_in = _A_setup()

    def _B_setup():
        B, S, D, F = 1, 2048, 640, 1536
        return {
            "x": _w((lambda *s: torch.randn(*s, dtype=torch.bfloat16) * 0.05)(B, S, D)),
            "w_gate": _w((lambda *s: torch.randn(*s, dtype=torch.bfloat16) * 0.8)(D, F) * (D ** -0.5)),
            "w_up": _w((lambda *s: torch.randn(*s, dtype=torch.bfloat16) * 0.8)(D, F) * (D ** -0.5)),
            "w_down": _w((lambda *s: torch.randn(*s, dtype=torch.bfloat16) * 0.8)(F, D) * (F ** -0.5)),
        }
    _B_in = _B_setup()

    return {
        "A_x": _A_in["x"],
        "A_Lambda_re": _A_in["Lambda_re"],
        "A_Lambda_im": _A_in["Lambda_im"],
        "A_B_re": _A_in["B_re"],
        "A_B_im": _A_in["B_im"],
        "A_C_re": _A_in["C_re"],
        "A_C_im": _A_in["C_im"],
        "A_log_dt": _A_in["log_dt"],
        "A_Dskip": _A_in["Dskip"],
        "B_x": _B_in["x"],
        "B_w_gate": _B_in["w_gate"],
        "B_w_up": _B_in["w_up"],
        "B_w_down": _B_in["w_down"],
        "gate_w": _w((lambda *s: torch.randn(*s, dtype=torch.bfloat16) * 0.05)(640) * 16.0),
    }

def reference(A_x, A_Lambda_re, A_Lambda_im, A_B_re, A_B_im, A_C_re, A_C_im, A_log_dt, A_Dskip, B_x, B_w_gate, B_w_up, B_w_down, gate_w):
    def _A_ref(x, Lambda_re, Lambda_im, B_re, B_im, C_re, C_im, log_dt, Dskip):
        Bsz, L, H = x.shape
        Lam = Lambda_re + 1j * Lambda_im
        Bmat = B_re + 1j * B_im
        Cmat = C_re + 1j * C_im
        dt = torch.exp(log_dt)
        Lam_bar = torch.exp(dt * Lam)
        B_bar = ((Lam_bar - 1.0) / Lam)[:, None] * Bmat
        Bu = torch.einsum("bld,pd->blp", x + 0j, B_bar)
        h = torch.zeros_like(Bu[:, 0, :])
        hs = []
        for t in range(L):
            h = Lam_bar[None, :] * h + Bu[:, t, :]
            hs.append(h)
        hseq = torch.stack(hs, 1)
        y = 2.0 * torch.einsum("blp,dp->bld", hseq, Cmat).real + x * Dskip[None, None, :]
        return y

    def _B_ref(x, w_gate, w_up, w_down):
        g = torch.einsum("bsd,df->bsf", x, w_gate)
        u = torch.einsum("bsd,df->bsf", x, w_up)
        h = g * u
        return torch.einsum("bsf,fd->bsd", h, w_down)

    x = A_x
    g = _sigmoid((x * gate_w).sum(-1, keepdims=True))
    a = _A_ref(x, A_Lambda_re, A_Lambda_im, A_B_re, A_B_im, A_C_re, A_C_im, A_log_dt, A_Dskip)
    b = _B_ref(x, B_w_gate, B_w_up, B_w_down)
    return g * a + (1 - g) * b
```

```asm
; @launch grid=(256,1,1) block=(256,1,1) lds=163840
.amdgcn_target "amdgcn-amd-amdhsa--gfx950"
.text
.globl gated_mix__ssm_conv_s5__glu_gated_bilinear__prompt_kernel
.p2align 8
.type gated_mix__ssm_conv_s5__glu_gated_bilinear__prompt_kernel,@function
gated_mix__ssm_conv_s5__glu_gated_bilinear__prompt_kernel:
    s_cmp_ge_u32 s2, 256
    s_cbranch_scc1 K_END
    s_load_dwordx16 s[64:79], s[0:1], 0
    s_load_dwordx16 s[80:95], s[0:1], 64
    s_load_dwordx2 s[96:97], s[0:1], 128
    s_getpc_b64 s[40:41]
K_PC:
    v_and_b32 v1, 63, v0
    v_lshrrev_b32 v56, 6, v0
    s_lshr_b32 s3, s2, 3
    s_lshl_b32 s3, s3, 11
    v_lshlrev_b32 v57, 3, v0
    v_add_u32 v57, s3, v57
    v_min_u32 v57, CODE_END-K_PC-8, v57
    global_load_dwordx2 a[216:217], v57, s[40:41]
    v_lshlrev_b32 v58, 4, v1
    s_getpc_b64 s[52:53]
TB_1:
    s_add_u32 s52, s52, LANETAB+0-TB_1
    s_addc_u32 s53, s53, 0
    global_load_dwordx4 v[18:21], v58, s[52:53] offset:0
    global_load_dwordx4 v[22:25], v58, s[52:53] offset:1024
    global_load_dwordx4 v[26:29], v58, s[52:53] offset:2048
    v_readfirstlane_b32 s4, v56
    s_and_b32 s3, s2, 7
    s_lshr_b32 s7, s2, 3
    s_and_b32 s5, s3, 1
    s_lshl_b32 s5, s5, 3
    s_and_b32 s42, s7, 7
    s_add_u32 s5, s5, s42
    s_lshr_b32 s6, s3, 1
    s_lshl_b32 s6, s6, 2
    s_lshr_b32 s42, s7, 3
    s_add_u32 s6, s6, s42
    s_and_b32 s60, s5, 7
    s_and_b32 s61, s6, 3
    s_mul_i32 s61, s61, 3
    s_add_u32 s60, s60, s61
    s_sub_u32 s61, s60, 10
    s_cmp_ge_u32 s60, 10
    s_cselect_b32 s60, s61, s60
    s_and_b32 s60, s5, 7
    s_and_b32 s61, s6, 3
    s_mul_i32 s61, s61, 2
    s_add_u32 s60, s60, s61
    s_sub_u32 s61, s60, 8
    s_cmp_ge_u32 s60, 8
    s_cselect_b32 s60, s61, s60
    s_sub_u32 s61, s60, 8
    s_cmp_ge_u32 s60, 8
    s_cselect_b32 s60, s61, s60
    s_add_u32 s60, s60, 2
    s_and_b32 s52, s3, 3
    s_lshl_b32 s52, s52, 3
    s_and_b32 s42, s7, 7
    s_add_u32 s52, s52, s42
    s_lshr_b32 s53, s3, 2
    s_lshl_b32 s53, s53, 2
    s_lshr_b32 s42, s7, 3
    s_add_u32 s53, s53, s42
    s_mov_b32 s3, s52
    s_mov_b32 s7, s53
    s_lshl_b32 s46, s4, 12
    s_lshl_b32 s48, s4, 11
    s_lshl_b32 s49, s4, 10
    v_lshrrev_b32 v56, 3, v1
    v_and_b32 v57, 7, v1
    v_lshrrev_b32 v58, 4, v1
    v_lshrrev_b32 v59, 5, v1
    v_and_b32 v60, 3, v56
    v_lshl_add_u32 v61, v59, 4, v60
    s_lshl_b32 s42, s5, 7
    s_lshl_b32 s43, s4, 5
    s_add_u32 s42, s42, s43
    v_add_u32 v61, s42, v61
    s_movk_i32 s55, 1280
    v_mul_lo_u32 v61, v61, s55
    v_xor_b32 v62, v57, v58
    v_xor_b32_e64 v63, 4, v62
    v_lshl_add_u32 v2, v62, 4, v61
    v_lshl_add_u32 v3, v63, 4, v61
    v_add_u32 v3, 4096, v3
    v_lshl_add_u32 v4, v62, 4, v61
    v_add_u32 v4, 8192, v4
    v_lshl_add_u32 v5, v63, 4, v61
    v_add_u32 v5, 12288, v5
    s_and_b32 s42, s4, 1
    s_mul_i32 s42, s42, 20
    v_add_u32 v64, s42, v56
    s_mul_i32 s54, s6, 40
    s_lshr_b32 s53, s4, 1
    s_lshl_b32 s53, s53, 2
    v_bfe_u32 v65, v64, 1, 3
    v_xor_b32 v65, v65, v57
    v_xor_b32 v65, s53, v65
    v_add_u32_e64 v66, s54, v64
    v_mul_lo_u32 v66, v66, s55
    v_lshl_add_u32 v6, v65, 4, v66
    v_add_u32_e64 v64, 8, v64
    v_bfe_u32 v65, v64, 1, 3
    v_xor_b32 v65, v65, v57
    v_xor_b32 v65, s53, v65
    v_add_u32_e64 v66, s54, v64
    v_mul_lo_u32 v66, v66, s55
    v_subrev_u32 v66, 1024, v66
    v_lshl_add_u32 v7, v65, 4, v66
    v_add_u32_e64 v64, 8, v64
    v_bfe_u32 v65, v64, 1, 3
    v_xor_b32 v65, v65, v57
    v_xor_b32 v65, s53, v65
    v_add_u32_e64 v66, s54, v64
    v_mul_lo_u32 v66, v66, s55
    v_subrev_u32 v66, 2048, v66
    v_lshl_add_u32 v8, v65, 4, v66
    s_lshr_b32 s47, s4, 1
    s_mul_i32 s47, s47, 5120
    s_and_b32 s42, s4, 1
    s_mul_i32 s42, s42, 2560
    s_add_u32 s47, s47, s42
    s_lshr_b32 s56, s6, 1
    s_mul_i32 s56, s56, 384
    s_and_b32 s57, s6, 1
    s_lshl_b32 s58, s57, 8
    s_add_u32 s58, s58, s56
    s_lshl_b32 s59, s57, 6
    s_add_u32 s59, s59, s56
    s_add_u32 s59, s59, 128
    s_lshl_b32 s42, s4, 4
    v_add_u32 v64, s42, v56
    s_movk_i32 s56, 3072
    v_mul_lo_u32 v64, v64, s56
    v_and_b32 v65, 1, v58
    v_lshlrev_b32 v65, 2, v65
    v_xor_b32_e64 v65, v65, v57
    v_lshl_add_u32 v64, v65, 4, v64
    v_add_u32_e64 v10, s58, v64
    v_add_u32 v11, 23552, v10
    v_lshrrev_b32 v64, 2, v1
    v_add_u32 v64, s42, v64
    v_mul_lo_u32 v64, v64, s56
    v_and_b32_e64 v65, 3, v1
    v_lshl_add_u32 v64, v65, 4, v64
    v_add_u32 v12, s59, v64
    s_waitcnt lgkmcnt(0)
    s_mov_b32 s8, s64
    s_and_b32 s9, s65, 0xffff
    s_mov_b32 s10, 2621440
    s_mov_b32 s11, 0x20000
    s_mov_b32 s83, s60
    s_mov_b32 s64, 0
    s_mov_b32 s65, 0
    s_add_u32 m0, s46, 0
    s_lshl_b32 s43, s64, 7
    buffer_load_dwordx4 v2, s[8:11], s43 offen lds
    v_lshlrev_b32 v99, 4, v0
    v_mov_b32 v100, 0
    v_mov_b32 v101, 0
    v_mov_b32 v102, 0
    v_mov_b32_e64 v103, 0
    buffer_load_dwordx4 v3, s[8:11], s43 offen offset:1024 lds
    v_add_u32 v99, 129408, v99
    ds_write_b128 v99, v[100:103]
    s_mov_b32 s32, s90
    s_and_b32 s33, s91, 0xffff
    s_mov_b32 s34, 1280
    s_mov_b32 s35, 0x20000
    v_lshlrev_b32 v64, 7, v1
    buffer_load_dword a246, v64, s[32:35], 0 offen
    buffer_load_dwordx4 v4, s[8:11], s43 offen offset:2048 lds
    v_and_b32 v68, 7, v1
    v_add_u32 v68, 32, v68
    v_cmp_gt_u32 vcc, 32, v1
    s_nop 1
    v_cndmask_b32 v68, v68, v1, vcc
    buffer_load_dwordx4 v5, s[8:11], s43 offen offset:3072 lds
    s_mul_i32 s54, s6, 40
    v_add_u32 v69, s54, v68
    v_lshlrev_b32 v69, 1, v69
    s_mov_b32 s32, s66
    s_and_b32 s33, s67, 0xffff
    s_mov_b32 s34, 1280
    s_mov_b32 s35, 0x20000
    buffer_load_ushort v108, v69, s[32:35], 0 offen
    s_cmp_ge_u32 s4, 2
    s_cselect_b32 s12, s72, s70
    s_cselect_b32 s13, s73, s71
    s_and_b32 s13, s13, 0xffff
    s_mov_b32 s14, 819200
    s_mov_b32 s15, 0x20000
    s_add_u32 m0, s47, 49152
    s_nop 0
    buffer_load_dwordx4 v6, s[12:15], s43 offen lds
    s_mov_b32 s32, s68
    s_and_b32 s33, s69, 0xffff
    s_mov_b32 s34, 1280
    s_mov_b32 s35, 0x20000
    buffer_load_ushort v109, v69, s[32:35], 0 offen
    buffer_load_dwordx4 v7, s[12:15], s43 offen offset:1024 lds
    s_mov_b32 s32, s78
    s_and_b32 s33, s79, 0xffff
    s_mov_b32 s34, 1280
    s_mov_b32 s35, 0x20000
    buffer_load_ushort v110, v69, s[32:35], 0 offen
    s_mov_b32 exec_hi, 0
    buffer_load_dwordx4 v8, s[12:15], s43 offen offset:2048 lds
    s_mov_b32 exec_hi, -1
    s_mov_b32 s36, s94
    s_and_b32 s37, s95, 0xffff
    s_mov_b32 s38, 256
    s_mov_b32 s39, 0x20000
    s_memrealtime s[40:41]
    s_waitcnt lgkmcnt(0)
    s_or_b32 s40, s40, 1
    v_accvgpr_write_b32 a255, s40
    s_or_b32 s52, s2, s4
    s_cmp_lg_u32 s52, 0
    s_cselect_b32 s52, 0x1000, 0
    s_mov_b64 exec, 1
    buffer_store_dword a255, off, s[36:39], s52 sc0 sc1
    s_mov_b64 exec, -1
    s_mov_b32 s20, s84
    s_and_b32 s21, s85, 0xffff
    s_mov_b32 s22, 1966080
    s_mov_b32 s23, 0x20000
    s_mov_b32 s24, s86
    s_and_b32 s25, s87, 0xffff
    s_mov_b32 s26, 1966080
    s_mov_b32 s27, 0x20000
    s_add_u32 m0, s48, 80256
    s_mul_i32 s45, s64, 196608
    buffer_load_dwordx4 v10, s[20:23], s45 offen lds
    s_mov_b32 s28, s96
    s_and_b32 s29, s97, 0xffff
    s_mov_b32 s30, 16777216
    s_mov_b32 s31, 0x20000
    buffer_load_dwordx4 v11, s[20:23], s45 offen offset:1024 lds
    s_add_u32 m0, s48, 88448
    s_nop 0
    buffer_load_dwordx4 v10, s[24:27], s45 offen lds
    buffer_load_dwordx4 v11, s[24:27], s45 offen offset:1024 lds
    s_add_u32 s64, s64, 1
    s_add_u32 m0, s46, 16384
    s_lshl_b32 s43, s64, 7
    buffer_load_dwordx4 v2, s[8:11], s43 offen lds
    buffer_load_dwordx4 v3, s[8:11], s43 offen offset:1024 lds
    buffer_load_dwordx4 v4, s[8:11], s43 offen offset:2048 lds
    buffer_load_dwordx4 v5, s[8:11], s43 offen offset:3072 lds
    s_add_u32 m0, s47, 59520
    s_nop 0
    buffer_load_dwordx4 v6, s[12:15], s43 offen lds
    buffer_load_dwordx4 v7, s[12:15], s43 offen offset:1024 lds
    s_mov_b32 exec_hi, 0
    buffer_load_dwordx4 v8, s[12:15], s43 offen offset:2048 lds
    s_mov_b32 exec_hi, -1
    s_add_u32 m0, s48, 96640
    s_mul_i32 s45, s64, 196608
    buffer_load_dwordx4 v10, s[20:23], s45 offen lds
    buffer_load_dwordx4 v11, s[20:23], s45 offen offset:1024 lds
    s_add_u32 m0, s48, 104832
    s_nop 0
    buffer_load_dwordx4 v10, s[24:27], s45 offen lds
    buffer_load_dwordx4 v11, s[24:27], s45 offen offset:1024 lds
    s_mov_b32 s64, s83
    s_waitcnt vmcnt(27)
    s_sub_u32 s52, s46, 49152
    v_add_u32 v14, s52, v18
    v_add_u32 v15, s52, v19
    v_add_u32 v16, s52, v20
    v_add_u32 v17, s52, v21
    v_add_u32 v0, 98304, v28
    s_waitcnt lgkmcnt(0)
    s_waitcnt vmcnt(11)
    s_barrier
    ds_read_b128 a[0:3], v14 offset:0
    ds_read_b128 a[160:163], v18 offset:0
    ds_read_b128 a[164:167], v20 offset:5120
    ds_read_b128 a[168:171], v22 offset:0
    ds_read_b64_tr_b16 a[172:173], v26 offset:0
    ds_read_b64_tr_b16 a[174:175], v26 offset:512
    ds_read_b64_tr_b16 a[176:177], v27 offset:0
    ds_read_b64_tr_b16 a[178:179], v27 offset:512
    ds_read_b64_tr_b16 a[180:181], v26 offset:8192
    ds_read_b64_tr_b16 a[182:183], v26 offset:8704
    ds_read_b64_tr_b16 a[184:185], v27 offset:8192
    ds_read_b64_tr_b16 a[186:187], v27 offset:8704
    s_waitcnt lgkmcnt(9)
    v_mfma_f32_32x32x16_bf16 v[112:127], a[0:3], a[160:163], 0
    s_add_u32 m0, s46, 32768
    s_lshl_b32 s43, s64, 7
    buffer_load_dwordx4 v2, s[8:11], s43 offen lds
    v_mfma_f32_32x32x16_bf16 v[128:143], a[0:3], a[164:167], 0
    ds_read_b128 a[4:7], v15 offset:0
    ds_read_b128 a[188:191], v19 offset:0
    ds_read_b128 a[192:195], v21 offset:5120
    buffer_load_dword v30, off, s[36:39], 0 sc0 sc1
    s_waitcnt lgkmcnt(9)
    v_mfma_f32_32x32x16_bf16 v[144:159], a[0:3], a[168:171], 0
    buffer_load_dwordx4 v3, s[8:11], s43 offen offset:1024 lds
    v_lshlrev_b32 v108, 16, v108
    v_lshlrev_b32 v109, 16, v109
    v_mfma_f32_32x32x16_bf16 v[160:175], a[172:175], a[0:3], 0
    ds_read_b128 a[196:199], v23 offset:0
    ds_read_b64_tr_b16 a[200:201], v26 offset:2048
    ds_read_b64_tr_b16 a[202:203], v26 offset:2560
    v_lshlrev_b32_e64 v110, 16, v110
    v_mul_f32 v86, 1069066811, v110
    s_waitcnt lgkmcnt(8)
    v_mfma_f32_32x32x16_bf16 v[176:191], a[176:179], a[0:3], 0
    buffer_load_dwordx4 v4, s[8:11], s43 offen offset:2048 lds
    v_exp_f32 v86, v86
    s_nop 0
    v_mfma_f32_32x32x16_bf16 v[192:207], a[180:183], a[0:3], 0
    ds_read_b64_tr_b16 a[204:205], v27 offset:2048
    ds_read_b64_tr_b16 a[206:207], v27 offset:2560
    ds_read_b64_tr_b16 a[208:209], v26 offset:10240
    v_cvt_pk_bf16_f32 v86, v86, v86
    v_lshlrev_b32 v86, 16, v86
    s_waitcnt lgkmcnt(9)
    v_mfma_f32_32x32x16_bf16 v[208:223], a[184:187], a[0:3], 0
    ds_read_b64_tr_b16 a[210:211], v26 offset:10752
    ds_read_b64_tr_b16 a[212:213], v27 offset:10240
    ds_read_b64_tr_b16 a[214:215], v27 offset:10752
    v_mul_f32 v84, v86, v108
    v_mul_f32 v85, v86, v109
    s_waitcnt lgkmcnt(9)
    v_mfma_f32_32x32x16_bf16 v[112:127], a[4:7], a[188:191], v[112:127]
    buffer_load_dwordx4 v5, s[8:11], s43 offen offset:3072 lds
    v_mul_f32 v84, 1069066811, v84
    v_mul_f32 v85, 1042479491, v85
    v_mfma_f32_32x32x16_bf16 v[128:143], a[4:7], a[192:195], v[128:143]
    ds_read_b128 a[8:11], v16 offset:0
    ds_read_b128 a[160:163], v20 offset:0
    ds_read_b128 a[164:167], v18 offset:5120
    v_exp_f32 v84, v84
    v_fract_f32 v85, v85
    s_waitcnt lgkmcnt(9)
    v_mfma_f32_32x32x16_bf16 v[144:159], a[4:7], a[196:199], v[144:159]
    s_add_u32 m0, s47, 69888
    s_nop 0
    buffer_load_dwordx4 v6, s[12:15], s43 offen lds
    v_mfma_f32_32x32x16_bf16 v[160:175], a[200:203], a[4:7], v[160:175]
    ds_read_b128 a[168:171], v24 offset:0
    ds_read_b64_tr_b16 a[172:173], v26 offset:4096
    ds_read_b64_tr_b16 a[174:175], v26 offset:4608
    s_nop 0
    v_cos_f32 v224, v85
    s_waitcnt lgkmcnt(8)
    v_mfma_f32_32x32x16_bf16 v[176:191], a[204:207], a[4:7], v[176:191]
    buffer_load_dwordx4 v7, s[12:15], s43 offen offset:1024 lds
    v_sin_f32 v225, v85
    s_nop 0
    v_mfma_f32_32x32x16_bf16 v[192:207], a[208:211], a[4:7], v[192:207]
    ds_read_b64_tr_b16 a[176:177], v27 offset:4096
    ds_read_b64_tr_b16 a[178:179], v27 offset:4608
    ds_read_b64_tr_b16 a[180:181], v26 offset:12288
    v_mul_f32 v224, v224, v84
    v_mul_f32 v225, v225, v84
    s_waitcnt lgkmcnt(9)
    v_mfma_f32_32x32x16_bf16 v[208:223], a[212:215], a[4:7], v[208:223]
    ds_read_b64_tr_b16 a[182:183], v26 offset:12800
    ds_read_b64_tr_b16 a[184:185], v27 offset:12288
    ds_read_b64_tr_b16 a[186:187], v27 offset:12800
    v_add_f32 v226, -1.0, v224
    v_mul_f32 v227, v108, v108
    s_waitcnt lgkmcnt(9)
    v_mfma_f32_32x32x16_bf16 v[112:127], a[8:11], a[160:163], v[112:127]
    s_mov_b32 exec_hi, 0
    buffer_load_dwordx4 v8, s[12:15], s43 offen offset:2048 lds
    s_mov_b32 exec_hi, -1
    v_mfma_f32_32x32x16_bf16 v[128:143], a[8:11], a[164:167], v[128:143]
    ds_read_b128 a[12:15], v17 offset:0
    ds_read_b128 a[188:191], v21 offset:0
    ds_read_b128 a[192:195], v19 offset:5120
    v_fmac_f32 v227, v109, v109
    v_rcp_f32 v227, v227
    s_waitcnt lgkmcnt(9)
    v_mfma_f32_32x32x16_bf16 v[144:159], a[8:11], a[168:171], v[144:159]
    s_add_u32 m0, s48, 113024
    s_mul_i32 s45, s64, 196608
    buffer_load_dwordx4 v10, s[20:23], s45 offen lds
    v_mfma_f32_32x32x16_bf16 v[160:175], a[172:175], a[8:11], v[160:175]
    ds_read_b128 a[196:199], v25 offset:0
    ds_read_b64_tr_b16 a[200:201], v26 offset:6144
    ds_read_b64_tr_b16 a[202:203], v26 offset:6656
    v_mul_f32 v228, v226, v108
    v_fmac_f32 v228, v225, v109
    s_waitcnt lgkmcnt(8)
    v_mfma_f32_32x32x16_bf16 v[176:191], a[176:179], a[8:11], v[176:191]
    buffer_load_dwordx4 v11, s[20:23], s45 offen offset:1024 lds
    v_mul_f32_e64 v229, v225, v108
    v_fma_f32 v229, -v226, v109, v229
    v_mfma_f32_32x32x16_bf16 v[192:207], a[180:183], a[8:11], v[192:207]
    ds_read_b64_tr_b16 a[204:205], v27 offset:6144
    ds_read_b64_tr_b16 a[206:207], v27 offset:6656
    ds_read_b64_tr_b16 a[208:209], v26 offset:14336
    v_mul_f32 v38, v228, v227
    v_mul_f32 v39, v229, v227
    s_waitcnt lgkmcnt(9)
    v_mfma_f32_32x32x16_bf16 v[208:223], a[184:187], a[8:11], v[208:223]
    ds_read_b64_tr_b16 a[210:211], v26 offset:14848
    ds_read_b64_tr_b16 a[212:213], v27 offset:14336
    ds_read_b64_tr_b16 a[214:215], v27 offset:14848
    v_mul_f32 v240, v224, v224
    v_add_f32_e64 v231, v224, v224
    v_fma_f32 v230, -v225, v225, v240
    v_mul_f32 v231, v231, v225
    s_waitcnt lgkmcnt(9)
    v_mfma_f32_32x32x16_bf16 v[112:127], a[12:15], a[188:191], v[112:127]
    s_add_u32 m0, s48, 121216
    s_nop 0
    buffer_load_dwordx4 v10, s[24:27], s45 offen lds
    v_mfma_f32_32x32x16_bf16 v[128:143], a[12:15], a[192:195], v[128:143]
    buffer_load_dwordx4 v11, s[24:27], s45 offen offset:1024 lds
    s_add_u32 s64, s64, 1
    s_cmp_eq_u32 s64, 10
    s_cselect_b32 s64, 2, s64
    s_waitcnt lgkmcnt(6)
    v_mfma_f32_32x32x16_bf16 v[144:159], a[12:15], a[196:199], v[144:159]
    v_mul_f32 v240, v230, v230
    v_add_f32_e64 v233, v230, v230
    v_fma_f32 v232, -v231, v231, v240
    v_mul_f32 v233, v233, v231
    v_mul_f32 v240, v232, v232
    v_add_f32_e64 v231, v232, v232
    v_fma_f32 v230, -v233, v233, v240
    v_mul_f32 v231, v231, v233
    v_mul_f32 v240, v230, v230
    v_add_f32_e64 v235, v230, v230
    v_fma_f32 v234, -v231, v231, v240
    v_mul_f32 v235, v235, v231
    v_mul_f32 v240, v234, v234
    v_add_f32_e64 v237, v234, v234
    v_fma_f32 v236, -v235, v235, v240
    v_mul_f32 v237, v237, v235
    v_mul_f32 v240, v236, v236
    v_add_f32_e64 v239, v236, v236
    v_fma_f32 v238, -v237, v237, v240
    v_mul_f32 v239, v239, v237
    v_mul_f32 v240, v238, v238
    v_add_f32_e64 v49, v238, v238
    v_fma_f32 v48, -v239, v239, v240
    v_mul_f32 v49, v49, v239
    v_mul_f32 v240, v48, v48
    v_add_f32_e64 v231, v48, v48
    v_fma_f32 v230, -v49, v49, v240
    v_mul_f32 v231, v231, v49
    v_mul_f32 v240, v230, v230
    v_add_f32_e64 v51, v230, v230
    v_fma_f32 v50, -v231, v231, v240
    v_mul_f32 v51, v51, v231
    s_and_b32 s52, s4, 1
    s_cmp_lg_u32 s52, 0
    s_cselect_b64 s[52:53], -1, 0
    v_mov_b32 v242, 1.0
    v_mov_b32 v243, 0
    v_cndmask_b32 v242, v242, v236, s[52:53]
    v_cndmask_b32 v243, v243, v237, s[52:53]
    s_and_b32 s52, s4, 2
    s_cmp_lg_u32 s52, 0
    s_cselect_b64 s[52:53], -1, 0
    v_mov_b32 v244, 1.0
    v_mov_b32_e64 v245, 0
    v_cndmask_b32 v244, v244, v238, s[52:53]
    v_cndmask_b32 v245, v245, v239, s[52:53]
    v_mul_f32 v246, v242, v244
    v_mul_f32 v247, v242, v245
    v_fma_f32 v246, -v243, v245, v246
    v_fmac_f32 v247, v243, v244
    v_mul_f32 v248, v246, v234
    v_mul_f32_e64 v249, v246, v235
    v_fma_f32 v248, -v247, v235, v248
    v_fmac_f32 v249, v247, v234
    v_mov_b32 v32, v224
    v_mov_b32 v40, v224
    v_mov_b32 v33, v225
    v_mov_b32 v41, v225
    v_mov_b32 v34, v234
    v_mov_b32 v42, v234
    v_mov_b32 v35, v235
    v_mov_b32 v43, v235
    v_mov_b32 v36, v246
    v_mov_b32 v44, v248
    v_mov_b32 v37, v247
    v_mov_b32 v45, v249
    v_mov_b32 v46, v38
    v_mov_b32 v47, v39
    v_permlane32_swap_b32 v32, v40
    v_permlane32_swap_b32 v33, v41
    v_permlane32_swap_b32 v34, v42
    v_permlane32_swap_b32 v35, v43
    v_permlane32_swap_b32 v36, v44
    v_permlane32_swap_b32 v37, v45
    v_permlane32_swap_b32 v38, v46
    v_permlane32_swap_b32 v39, v47
    s_waitcnt vmcnt(12) lgkmcnt(0)
    s_barrier
    v_mfma_f32_32x32x16_bf16 v[160:175], a[200:203], a[12:15], v[160:175]
    ds_read_b128 a[16:19], v14 offset:16384
    ds_read_b128 a[160:163], v18 offset:10368
    ds_read_b128 a[164:167], v20 offset:15488
    s_lshl_b32 s52, s2, 2
    s_add_u32 s52, s52, s4
    s_cmp_ge_u32 s52, 880
    s_cbranch_scc1 PKN_4
    s_cmp_ge_u32 s52, 480
    s_cbranch_scc1 PKS_2
    s_mul_i32 s53, s52, 6554
    s_lshr_b32 s53, s53, 16
    s_mul_i32 s54, s53, 10
    s_sub_u32 s54, s52, s54
    s_lshr_b32 s55, s53, 1
    s_sub_u32 s56, s53, 32
    s_cmp_lt_u32 s53, 32
    s_cselect_b32 s55, s55, s56
    s_and_b32 s56, s55, 1
    s_lshl_b32 s57, s56, 2
    s_and_b32 s58, s53, 1
    s_add_u32 s57, s57, s58
    s_add_u32 s58, s56, 2
    s_cmp_lt_u32 s53, 32
    s_cselect_b32 s57, s57, s58
    s_lshr_b32 s55, s55, 1
    s_mul_i32 s55, s55, 6
    s_add_u32 s55, s55, s57
    s_mov_b32 s32, s88
    s_and_b32 s33, s89, 0xffff
    s_mov_b32 s34, 1966080
    s_mov_b32 s35, 0x20000
    s_mul_i32 s55, s55, 40960
    s_lshl_b32 s56, s54, 7
    s_add_u32 s59, s55, s56
    s_mov_b32 s99, 1
    s_mov_b32 s100, s53
    s_mov_b32 s101, s54
    s_branch PKE_3
PKS_2:
    s_sub_u32 s52, s52, 480
    s_cmp_ge_u32 s52, 200
    s_cselect_b32 s53, 1, 0
    s_mul_i32 s54, s53, 200
    s_sub_u32 s52, s52, s54
    s_mul_i32 s54, s52, 52429
    s_lshr_b32 s54, s54, 18
    s_mul_i32 s55, s54, 5
    s_sub_u32 s55, s52, s55
    s_cmp_lg_u32 s53, 0
    s_cselect_b32 s32, s76, s74
    s_cselect_b32 s33, s77, s75
    s_and_b32 s33, s33, 0xffff
    s_mov_b32 s34, 819200
    s_mov_b32 s35, 0x20000
    s_mul_i32 s57, s54, 20480
    s_lshl_b32 s58, s55, 8
    s_add_u32 s59, s57, s58
    s_lshl_b32 s55, s55, 3
    s_add_u32 s55, s55, 48
    s_add_u32 s55, s55, s53
    s_mov_b32 s99, 2
    s_mov_b32 s100, s55
    s_mov_b32 s101, s54
    s_branch PKE_3
PKN_4:
    s_mov_b32 s32, s88
    s_and_b32 s33, s89, 0xffff
    s_mov_b32 s34, 1966080
    s_mov_b32 s35, 0x20000
    s_mov_b32 s59, 0
    s_mov_b32 s99, 0
    s_mov_b32 s100, 0
    s_mov_b32 s101, 0
PKE_3:
    s_mov_b32 s88, s59
    v_lshlrev_b32 v56, 4, v1
    s_getpc_b64 s[52:53]
TB_5:
    s_add_u32 s52, s52, LANETAB+7168-TB_5
    s_addc_u32 s53, s53, 0
    s_cmp_eq_u32 s99, 2
    s_cselect_b32 s54, 1024, 0
    s_add_u32 s52, s52, s54
    s_addc_u32 s53, s53, 0
    global_load_dwordx4 v[80:83], v56, s[52:53] offset:0
    v_mfma_f32_32x32x16_bf16 v[176:191], a[204:207], a[12:15], v[176:191]
    ds_read_b128 a[168:171], v22 offset:10368
    ds_read_b64_tr_b16 a[172:173], v26 offset:16384
    ds_read_b64_tr_b16 a[174:175], v26 offset:16896
    s_mov_b32 s16, s80
    s_and_b32 s17, s81, 0xffff
    s_mov_b32 s18, 1280
    s_mov_b32 s19, 0x20000
    v_lshlrev_b32 v88, 7, v1
    buffer_load_dword a247, v88, s[16:19], 0 offen
    v_mfma_f32_32x32x16_bf16 v[192:207], a[208:211], a[12:15], v[192:207]
    ds_read_b64_tr_b16 a[176:177], v27 offset:16384
    ds_read_b64_tr_b16 a[178:179], v27 offset:16896
    ds_read_b64_tr_b16 a[180:181], v26 offset:24576
    s_lshl_b32 s53, s5, 3
    s_lshl_b32 s54, s4, 1
    s_add_u32 s53, s53, s54
    s_mul_i32 s53, s53, 88
    v_mfma_f32_32x32x16_bf16 v[208:223], a[212:215], a[12:15], v[208:223]
    ds_read_b64_tr_b16 a[182:183], v26 offset:25088
    ds_read_b64_tr_b16 a[184:185], v27 offset:24576
    ds_read_b64_tr_b16 a[186:187], v27 offset:25088
    s_lshl_b32 s52, s6, 1
    s_add_u32 s52, s52, s53
    s_lshl_b32 s66, s52, 10
    s_add_u32 s67, s66, 1024
    s_waitcnt lgkmcnt(9)
    v_mfma_f32_32x32x16_bf16 v[112:127], a[16:19], a[160:163], v[112:127]
    s_add_u32 m0, s46, 0
    s_lshl_b32 s43, s64, 7
    buffer_load_dwordx4 v2, s[8:11], s43 offen lds
    v_mfma_f32_32x32x16_bf16 v[128:143], a[16:19], a[164:167], v[128:143]
    ds_read_b128 a[20:23], v15 offset:16384
    ds_read_b128 a[188:191], v19 offset:10368
    ds_read_b128 a[192:195], v21 offset:15488
    s_add_u32 s52, s6, 32
    s_add_u32 s52, s52, s53
    s_lshl_b32 s68, s52, 10
    s_waitcnt lgkmcnt(9)
    v_mfma_f32_32x32x16_bf16 v[144:159], a[16:19], a[168:171], v[144:159]
    buffer_load_dwordx4 v3, s[8:11], s43 offen offset:1024 lds
    s_mul_i32 s54, s6, 5
    s_add_u32 s55, s53, 48
    s_lshl_b32 s55, s55, 10
    s_lshl_b32 s56, s54, 8
    s_add_u32 s55, s55, s56
    v_mfma_f32_32x32x16_bf16 v[160:175], a[172:175], a[16:19], v[160:175]
    ds_read_b128 a[196:199], v23 offset:10368
    ds_read_b64_tr_b16 a[200:201], v26 offset:18432
    ds_read_b64_tr_b16 a[202:203], v26 offset:18944
    s_add_u32 s56, s54, 0
    s_lshr_b32 s56, s56, 2
    s_lshl_b32 s56, s56, 10
    s_add_u32 s56, s56, 0
    s_add_u32 s74, s56, s55
    s_waitcnt lgkmcnt(8)
    v_mfma_f32_32x32x16_bf16 v[176:191], a[176:179], a[16:19], v[176:191]
    buffer_load_dwordx4 v4, s[8:11], s43 offen offset:2048 lds
    s_add_u32 s56, s54, 1
    s_lshr_b32 s56, s56, 2
    s_lshl_b32 s56, s56, 10
    s_add_u32 s56, s56, 256
    s_add_u32 s75, s56, s55
    v_mfma_f32_32x32x16_bf16 v[192:207], a[180:183], a[16:19], v[192:207]
    ds_read_b64_tr_b16 a[204:205], v27 offset:18432
    ds_read_b64_tr_b16 a[206:207], v27 offset:18944
    ds_read_b64_tr_b16 a[208:209], v26 offset:26624
    s_add_u32 s56, s54, 2
    s_lshr_b32 s56, s56, 2
    s_lshl_b32 s56, s56, 10
    s_add_u32 s56, s56, 512
    s_add_u32 s76, s56, s55
    s_waitcnt lgkmcnt(9)
    v_mfma_f32_32x32x16_bf16 v[208:223], a[184:187], a[16:19], v[208:223]
    ds_read_b64_tr_b16 a[210:211], v26 offset:27136
    ds_read_b64_tr_b16 a[212:213], v27 offset:26624
    ds_read_b64_tr_b16 a[214:215], v27 offset:27136
    s_add_u32 s56, s54, 3
    s_lshr_b32 s56, s56, 2
    s_lshl_b32 s56, s56, 10
    s_add_u32 s56, s56, 768
    s_add_u32 s77, s56, s55
    s_waitcnt lgkmcnt(9)
    v_mfma_f32_32x32x16_bf16 v[112:127], a[20:23], a[188:191], v[112:127]
    buffer_load_dwordx4 v5, s[8:11], s43 offen offset:3072 lds
    s_add_u32 s56, s54, 4
    s_lshr_b32 s56, s56, 2
    s_lshl_b32 s56, s56, 10
    s_add_u32 s56, s56, 1024
    s_add_u32 s78, s56, s55
    v_mfma_f32_32x32x16_bf16 v[128:143], a[20:23], a[192:195], v[128:143]
    ds_read_b128 a[24:27], v16 offset:16384
    ds_read_b128 a[160:163], v20 offset:10368
    ds_read_b128 a[164:167], v18 offset:15488
    s_lshl_b32 s52, s6, 4
    s_add_u32 s52, s52, s5
    s_mul_i32 s52, s52, 640
    s_add_u32 s52, s52, 15204352
    s_waitcnt lgkmcnt(9)
    v_mfma_f32_32x32x16_bf16 v[144:159], a[20:23], a[196:199], v[144:159]
    s_add_u32 m0, s47, 49152
    s_nop 0
    buffer_load_dwordx4 v6, s[12:15], s43 offen lds
    v_mfma_f32_32x32x16_bf16 v[160:175], a[200:203], a[20:23], v[160:175]
    ds_read_b128 a[168:171], v24 offset:10368
    ds_read_b64_tr_b16 a[172:173], v26 offset:20480
    ds_read_b64_tr_b16 a[174:175], v26 offset:20992
    s_mov_b32 s55, s52
    s_cmp_lg_u32 s4, 3
    s_cselect_b32 s69, 0x7ff00000, s52
    s_waitcnt lgkmcnt(8)
    v_mfma_f32_32x32x16_bf16 v[176:191], a[204:207], a[20:23], v[176:191]
    buffer_load_dwordx4 v7, s[12:15], s43 offen offset:1024 lds
    s_lshl_b32 s52, s5, 6
    s_lshl_b32 s53, s6, 2
    s_add_u32 s52, s52, s53
    s_add_u32 s52, s52, 15466496
    v_mfma_f32_32x32x16_bf16 v[192:207], a[208:211], a[20:23], v[192:207]
    ds_read_b64_tr_b16 a[176:177], v27 offset:20480
    ds_read_b64_tr_b16 a[178:179], v27 offset:20992
    ds_read_b64_tr_b16 a[180:181], v26 offset:28672
    s_cmp_lg_u32 s4, 0
    s_cselect_b32 s70, 0x7ff00000, s52
    s_waitcnt lgkmcnt(9)
    v_mfma_f32_32x32x16_bf16 v[208:223], a[212:215], a[20:23], v[208:223]
    ds_read_b64_tr_b16 a[182:183], v26 offset:29184
    ds_read_b64_tr_b16 a[184:185], v27 offset:28672
    ds_read_b64_tr_b16 a[186:187], v27 offset:29184
    s_add_u32 s71, s70, 1024
    s_add_u32 s72, s70, 2048
    s_add_u32 s97, s70, 3072
    s_waitcnt lgkmcnt(9)
    v_mfma_f32_32x32x16_bf16 v[112:127], a[24:27], a[160:163], v[112:127]
    s_mov_b32 exec_hi, 0
    buffer_load_dwordx4 v8, s[12:15], s43 offen offset:2048 lds
    s_mov_b32 exec_hi, -1
    v_mfma_f32_32x32x16_bf16 v[128:143], a[24:27], a[164:167], v[128:143]
    ds_read_b128 a[28:31], v17 offset:16384
    ds_read_b128 a[188:191], v21 offset:10368
    ds_read_b128 a[192:195], v19 offset:15488
    s_lshl_b32 s52, s2, 2
    s_add_u32 s52, s52, 15474688
    s_cmp_lg_u32 s4, 0
    s_cselect_b32 s73, 0x7ff00000, s52
    s_waitcnt lgkmcnt(9)
    v_mfma_f32_32x32x16_bf16 v[144:159], a[24:27], a[168:171], v[144:159]
    s_add_u32 m0, s48, 80256
    s_mul_i32 s45, s64, 196608
    buffer_load_dwordx4 v10, s[20:23], s45 offen lds
    v_mfma_f32_32x32x16_bf16 v[160:175], a[172:175], a[24:27], v[160:175]
    ds_read_b128 a[196:199], v25 offset:10368
    ds_read_b64_tr_b16 a[200:201], v26 offset:22528
    ds_read_b64_tr_b16 a[202:203], v26 offset:23040
    s_lshr_b32 s52, s3, 1
    s_lshl_b32 s52, s52, 6
    s_add_u32 s79, s52, 15466496
    s_waitcnt lgkmcnt(8)
    v_mfma_f32_32x32x16_bf16 v[176:191], a[176:179], a[24:27], v[176:191]
    buffer_load_dwordx4 v11, s[20:23], s45 offen offset:1024 lds
    s_lshl_b32 s52, s4, 2
    s_add_u32 s52, s52, 1
    s_mul_i32 s53, s52, 640
    s_sub_u32 s53, s55, s53
    v_mfma_f32_32x32x16_bf16 v[192:207], a[180:183], a[24:27], v[192:207]
    ds_read_b64_tr_b16 a[204:205], v27 offset:22528
    ds_read_b64_tr_b16 a[206:207], v27 offset:23040
    ds_read_b64_tr_b16 a[208:209], v26 offset:30720
    s_cmp_ge_u32 s5, s52
    s_cselect_b32 s84, s53, 0x7ff00000
    s_add_u32 s52, s52, 1
    s_sub_u32 s53, s53, 640
    s_waitcnt lgkmcnt(9)
    v_mfma_f32_32x32x16_bf16 v[208:223], a[184:187], a[24:27], v[208:223]
    ds_read_b64_tr_b16 a[210:211], v26 offset:31232
    ds_read_b64_tr_b16 a[212:213], v27 offset:30720
    ds_read_b64_tr_b16 a[214:215], v27 offset:31232
    s_cmp_ge_u32 s5, s52
    s_cselect_b32 s85, s53, 0x7ff00000
    s_add_u32 s52, s52, 1
    s_sub_u32 s53, s53, 640
    s_waitcnt lgkmcnt(9)
    v_mfma_f32_32x32x16_bf16 v[112:127], a[28:31], a[188:191], v[112:127]
    s_add_u32 m0, s48, 88448
    s_nop 0
    buffer_load_dwordx4 v10, s[24:27], s45 offen lds
    v_mfma_f32_32x32x16_bf16 v[128:143], a[28:31], a[192:195], v[128:143]
    buffer_load_dwordx4 v11, s[24:27], s45 offen offset:1024 lds
    s_add_u32 s64, s64, 1
    s_cmp_eq_u32 s64, 10
    s_cselect_b32 s64, 2, s64
    s_waitcnt lgkmcnt(6)
    v_mfma_f32_32x32x16_bf16 v[144:159], a[28:31], a[196:199], v[144:159]
    s_waitcnt vmcnt(13) lgkmcnt(0)
    s_barrier
    v_mfma_f32_32x32x16_bf16 v[160:175], a[200:203], a[28:31], v[160:175]
    ds_read_b128 a[32:35], v14 offset:32768
    ds_read_b128 a[160:163], v18 offset:20736
    ds_read_b128 a[164:167], v20 offset:25856
    s_cmp_ge_u32 s5, s52
    s_cselect_b32 s86, s53, 0x7ff00000
    s_add_u32 s52, s52, 1
    s_sub_u32 s53, s53, 640
    v_mfma_f32_32x32x16_bf16 v[176:191], a[204:207], a[28:31], v[176:191]
    ds_read_b128 a[168:171], v22 offset:20736
    ds_read_b64_tr_b16 a[172:173], v26 offset:32768
    ds_read_b64_tr_b16 a[174:175], v26 offset:33280
    s_cmp_ge_u32 s5, s52
    s_cselect_b32 s87, s53, 0x7ff00000
    s_lshl_b32 s44, s3, 2
    s_add_u32 s44, s44, s4
    s_mul_i32 s44, s44, 90112
    v_mfma_f32_32x32x16_bf16 v[192:207], a[208:211], a[28:31], v[192:207]
    ds_read_b64_tr_b16 a[176:177], v27 offset:32768
    ds_read_b64_tr_b16 a[178:179], v27 offset:33280
    ds_read_b64_tr_b16 a[180:181], v26 offset:40960
    s_mul_i32 s51, s7, 88
    s_add_u32 s51, s51, s4
    s_mul_i32 s51, s51, 5120
    s_add_u32 s51, s51, 11534336
    v_mfma_f32_32x32x16_bf16 v[208:223], a[212:215], a[28:31], v[208:223]
    ds_read_b64_tr_b16 a[182:183], v26 offset:41472
    ds_read_b64_tr_b16 a[184:185], v27 offset:40960
    ds_read_b64_tr_b16 a[186:187], v27 offset:41472
    s_mul_i32 s98, s4, 5120
    v_lshlrev_b32 v60, 4, v1
    s_getpc_b64 s[52:53]
TB_6:
    s_add_u32 s52, s52, LANETAB+9216-TB_6
    s_addc_u32 s53, s53, 0
    s_cmp_eq_u32 s99, 2
    s_cselect_b32 s54, 1024, 0
    s_add_u32 s52, s52, s54
    s_addc_u32 s53, s53, 0
    global_load_dwordx4 v[56:59], v60, s[52:53] offset:0
    s_waitcnt lgkmcnt(9)
    v_mfma_f32_32x32x16_bf16 v[112:127], a[32:35], a[160:163], v[112:127]
    s_add_u32 m0, s46, 16384
    s_lshl_b32 s43, s64, 7
    buffer_load_dwordx4 v2, s[8:11], s43 offen lds
    v_mfma_f32_32x32x16_bf16 v[128:143], a[32:35], a[164:167], v[128:143]
    ds_read_b128 a[36:39], v15 offset:32768
    ds_read_b128 a[188:191], v19 offset:20736
    ds_read_b128 a[192:195], v21 offset:25856
    s_waitcnt lgkmcnt(9)
    v_mfma_f32_32x32x16_bf16 v[144:159], a[32:35], a[168:171], v[144:159]
    buffer_load_dwordx4 v3, s[8:11], s43 offen offset:1024 lds
    v_mfma_f32_32x32x16_bf16 v[160:175], a[172:175], a[32:35], v[160:175]
    ds_read_b128 a[196:199], v23 offset:20736
    ds_read_b64_tr_b16 a[200:201], v26 offset:34816
    ds_read_b64_tr_b16 a[202:203], v26 offset:35328
    s_waitcnt lgkmcnt(8)
    v_mfma_f32_32x32x16_bf16 v[176:191], a[176:179], a[32:35], v[176:191]
    buffer_load_dwordx4 v4, s[8:11], s43 offen offset:2048 lds
    v_mfma_f32_32x32x16_bf16 v[192:207], a[180:183], a[32:35], v[192:207]
    ds_read_b64_tr_b16 a[204:205], v27 offset:34816
    ds_read_b64_tr_b16 a[206:207], v27 offset:35328
    ds_read_b64_tr_b16 a[208:209], v26 offset:43008
    s_waitcnt lgkmcnt(9)
    v_mfma_f32_32x32x16_bf16 v[208:223], a[184:187], a[32:35], v[208:223]
    ds_read_b64_tr_b16 a[210:211], v26 offset:43520
    ds_read_b64_tr_b16 a[212:213], v27 offset:43008
    ds_read_b64_tr_b16 a[214:215], v27 offset:43520
    s_waitcnt lgkmcnt(9)
    v_mfma_f32_32x32x16_bf16 v[112:127], a[36:39], a[188:191], v[112:127]
    buffer_load_dwordx4 v5, s[8:11], s43 offen offset:3072 lds
    v_mfma_f32_32x32x16_bf16 v[128:143], a[36:39], a[192:195], v[128:143]
    ds_read_b128 a[40:43], v16 offset:32768
    ds_read_b128 a[160:163], v20 offset:20736
    ds_read_b128 a[164:167], v18 offset:25856
    s_waitcnt lgkmcnt(9)
    v_mfma_f32_32x32x16_bf16 v[144:159], a[36:39], a[196:199], v[144:159]
    s_add_u32 m0, s47, 59520
    s_nop 0
    buffer_load_dwordx4 v6, s[12:15], s43 offen lds
    v_mfma_f32_32x32x16_bf16 v[160:175], a[200:203], a[36:39], v[160:175]
    ds_read_b128 a[168:171], v24 offset:20736
    ds_read_b64_tr_b16 a[172:173], v26 offset:36864
    ds_read_b64_tr_b16 a[174:175], v26 offset:37376
    s_waitcnt lgkmcnt(8)
    v_mfma_f32_32x32x16_bf16 v[176:191], a[204:207], a[36:39], v[176:191]
    buffer_load_dwordx4 v7, s[12:15], s43 offen offset:1024 lds
    v_mfma_f32_32x32x16_bf16 v[192:207], a[208:211], a[36:39], v[192:207]
    ds_read_b64_tr_b16 a[176:177], v27 offset:36864
    ds_read_b64_tr_b16 a[178:179], v27 offset:37376
    ds_read_b64_tr_b16 a[180:181], v26 offset:45056
    s_waitcnt lgkmcnt(9)
    v_mfma_f32_32x32x16_bf16 v[208:223], a[212:215], a[36:39], v[208:223]
    ds_read_b64_tr_b16 a[182:183], v26 offset:45568
    ds_read_b64_tr_b16 a[184:185], v27 offset:45056
    ds_read_b64_tr_b16 a[186:187], v27 offset:45568
    s_waitcnt lgkmcnt(9)
    v_mfma_f32_32x32x16_bf16 v[112:127], a[40:43], a[160:163], v[112:127]
    s_mov_b32 exec_hi, 0
    buffer_load_dwordx4 v8, s[12:15], s43 offen offset:2048 lds
    s_mov_b32 exec_hi, -1
    v_mfma_f32_32x32x16_bf16 v[128:143], a[40:43], a[164:167], v[128:143]
    ds_read_b128 a[44:47], v17 offset:32768
    ds_read_b128 a[188:191], v21 offset:20736
    ds_read_b128 a[192:195], v19 offset:25856
    s_waitcnt lgkmcnt(9)
    v_mfma_f32_32x32x16_bf16 v[144:159], a[40:43], a[168:171], v[144:159]
    s_add_u32 m0, s48, 96640
    s_mul_i32 s45, s64, 196608
    buffer_load_dwordx4 v10, s[20:23], s45 offen lds
    v_mfma_f32_32x32x16_bf16 v[160:175], a[172:175], a[40:43], v[160:175]
    ds_read_b128 a[196:199], v25 offset:20736
    ds_read_b64_tr_b16 a[200:201], v26 offset:38912
    ds_read_b64_tr_b16 a[202:203], v26 offset:39424
    s_waitcnt lgkmcnt(8)
    v_mfma_f32_32x32x16_bf16 v[176:191], a[176:179], a[40:43], v[176:191]
    buffer_load_dwordx4 v11, s[20:23], s45 offen offset:1024 lds
    v_mfma_f32_32x32x16_bf16 v[192:207], a[180:183], a[40:43], v[192:207]
    ds_read_b64_tr_b16 a[204:205], v27 offset:38912
    ds_read_b64_tr_b16 a[206:207], v27 offset:39424
    ds_read_b64_tr_b16 a[208:209], v26 offset:47104
    s_waitcnt lgkmcnt(9)
    v_mfma_f32_32x32x16_bf16 v[208:223], a[184:187], a[40:43], v[208:223]
    ds_read_b64_tr_b16 a[210:211], v26 offset:47616
    ds_read_b64_tr_b16 a[212:213], v27 offset:47104
    ds_read_b64_tr_b16 a[214:215], v27 offset:47616
    s_waitcnt lgkmcnt(9)
    v_mfma_f32_32x32x16_bf16 v[112:127], a[44:47], a[188:191], v[112:127]
    s_add_u32 m0, s48, 104832
    s_nop 0
    buffer_load_dwordx4 v10, s[24:27], s45 offen lds
    v_mfma_f32_32x32x16_bf16 v[128:143], a[44:47], a[192:195], v[128:143]
    buffer_load_dwordx4 v11, s[24:27], s45 offen offset:1024 lds
    s_add_u32 s64, s64, 1
    s_cmp_eq_u32 s64, 10
    s_cselect_b32 s64, 2, s64
    s_waitcnt lgkmcnt(6)
    v_mfma_f32_32x32x16_bf16 v[144:159], a[44:47], a[196:199], v[144:159]
    s_waitcnt vmcnt(12) lgkmcnt(0)
    s_barrier
    s_add_u32 m0, s46, 139136
    s_nop 0
    buffer_load_dwordx4 v80, s[32:35], s88 offen offset:0 lds
    buffer_load_dwordx4 v81, s[32:35], s88 offen offset:1024 lds
    buffer_load_dwordx4 v82, s[32:35], s88 offen offset:2048 lds
    buffer_load_dwordx4 v83, s[32:35], s88 offen offset:3072 lds
    v_mfma_f32_32x32x16_bf16 v[160:175], a[200:203], a[44:47], v[160:175]
    ds_read_b128 a[48:51], v14 offset:0
    ds_read_b128 a[160:163], v18 offset:0
    ds_read_b128 a[164:167], v20 offset:5120
    v_mfma_f32_32x32x16_bf16 v[176:191], a[204:207], a[44:47], v[176:191]
    ds_read_b128 a[168:171], v22 offset:0
    ds_read_b64_tr_b16 a[172:173], v26 offset:0
    ds_read_b64_tr_b16 a[174:175], v26 offset:512
    v_mfma_f32_32x32x16_bf16 v[192:207], a[208:211], a[44:47], v[192:207]
    ds_read_b64_tr_b16 a[176:177], v27 offset:0
    ds_read_b64_tr_b16 a[178:179], v27 offset:512
    ds_read_b64_tr_b16 a[180:181], v26 offset:8192
    v_mfma_f32_32x32x16_bf16 v[208:223], a[212:215], a[44:47], v[208:223]
    ds_read_b64_tr_b16 a[182:183], v26 offset:8704
    ds_read_b64_tr_b16 a[184:185], v27 offset:8192
    ds_read_b64_tr_b16 a[186:187], v27 offset:8704
    s_waitcnt lgkmcnt(9)
    v_mfma_f32_32x32x16_bf16 v[112:127], a[48:51], a[160:163], v[112:127]
    s_add_u32 m0, s46, 32768
    s_lshl_b32 s43, s64, 7
    buffer_load_dwordx4 v2, s[8:11], s43 offen lds
    v_mfma_f32_32x32x16_bf16 v[128:143], a[48:51], a[164:167], v[128:143]
    ds_read_b128 a[52:55], v15 offset:0
    ds_read_b128 a[188:191], v19 offset:0
    ds_read_b128 a[192:195], v21 offset:5120
    s_waitcnt lgkmcnt(9)
    v_mfma_f32_32x32x16_bf16 v[144:159], a[48:51], a[168:171], v[144:159]
    buffer_load_dwordx4 v3, s[8:11], s43 offen offset:1024 lds
    v_mfma_f32_32x32x16_bf16 v[160:175], a[172:175], a[48:51], v[160:175]
    ds_read_b128 a[196:199], v23 offset:0
    ds_read_b64_tr_b16 a[200:201], v26 offset:2048
    ds_read_b64_tr_b16 a[202:203], v26 offset:2560
    s_waitcnt lgkmcnt(8)
    v_mfma_f32_32x32x16_bf16 v[176:191], a[176:179], a[48:51], v[176:191]
    buffer_load_dwordx4 v4, s[8:11], s43 offen offset:2048 lds
    v_mfma_f32_32x32x16_bf16 v[192:207], a[180:183], a[48:51], v[192:207]
    ds_read_b64_tr_b16 a[204:205], v27 offset:2048
    ds_read_b64_tr_b16 a[206:207], v27 offset:2560
    ds_read_b64_tr_b16 a[208:209], v26 offset:10240
    s_waitcnt lgkmcnt(9)
    v_mfma_f32_32x32x16_bf16 v[208:223], a[184:187], a[48:51], v[208:223]
    ds_read_b64_tr_b16 a[210:211], v26 offset:10752
    ds_read_b64_tr_b16 a[212:213], v27 offset:10240
    ds_read_b64_tr_b16 a[214:215], v27 offset:10752
    s_waitcnt lgkmcnt(9)
    v_mfma_f32_32x32x16_bf16 v[112:127], a[52:55], a[188:191], v[112:127]
    buffer_load_dwordx4 v5, s[8:11], s43 offen offset:3072 lds
    v_mfma_f32_32x32x16_bf16 v[128:143], a[52:55], a[192:195], v[128:143]
    ds_read_b128 a[56:59], v16 offset:0
    ds_read_b128 a[160:163], v20 offset:0
    ds_read_b128 a[164:167], v18 offset:5120
    s_waitcnt lgkmcnt(9)
    v_mfma_f32_32x32x16_bf16 v[144:159], a[52:55], a[196:199], v[144:159]
    s_add_u32 m0, s47, 69888
    s_nop 0
    buffer_load_dwordx4 v6, s[12:15], s43 offen lds
    v_mfma_f32_32x32x16_bf16 v[160:175], a[200:203], a[52:55], v[160:175]
    ds_read_b128 a[168:171], v24 offset:0
    ds_read_b64_tr_b16 a[172:173], v26 offset:4096
    ds_read_b64_tr_b16 a[174:175], v26 offset:4608
    s_waitcnt lgkmcnt(8)
    v_mfma_f32_32x32x16_bf16 v[176:191], a[204:207], a[52:55], v[176:191]
    buffer_load_dwordx4 v7, s[12:15], s43 offen offset:1024 lds
    v_mfma_f32_32x32x16_bf16 v[192:207], a[208:211], a[52:55], v[192:207]
    ds_read_b64_tr_b16 a[176:177], v27 offset:4096
    ds_read_b64_tr_b16 a[178:179], v27 offset:4608
    ds_read_b64_tr_b16 a[180:181], v26 offset:12288
    s_waitcnt lgkmcnt(9)
    v_mfma_f32_32x32x16_bf16 v[208:223], a[212:215], a[52:55], v[208:223]
    ds_read_b64_tr_b16 a[182:183], v26 offset:12800
    ds_read_b64_tr_b16 a[184:185], v27 offset:12288
    ds_read_b64_tr_b16 a[186:187], v27 offset:12800
    s_waitcnt lgkmcnt(9)
    v_mfma_f32_32x32x16_bf16 v[112:127], a[56:59], a[160:163], v[112:127]
    s_mov_b32 exec_hi, 0
    buffer_load_dwordx4 v8, s[12:15], s43 offen offset:2048 lds
    s_mov_b32 exec_hi, -1
    v_mfma_f32_32x32x16_bf16 v[128:143], a[56:59], a[164:167], v[128:143]
    ds_read_b128 a[60:63], v17 offset:0
    ds_read_b128 a[188:191], v21 offset:0
    ds_read_b128 a[192:195], v19 offset:5120
    s_waitcnt lgkmcnt(9)
    v_mfma_f32_32x32x16_bf16 v[144:159], a[56:59], a[168:171], v[144:159]
    s_add_u32 m0, s48, 113024
    s_mul_i32 s45, s64, 196608
    buffer_load_dwordx4 v10, s[20:23], s45 offen lds
    v_mfma_f32_32x32x16_bf16 v[160:175], a[172:175], a[56:59], v[160:175]
    ds_read_b128 a[196:199], v25 offset:0
    ds_read_b64_tr_b16 a[200:201], v26 offset:6144
    ds_read_b64_tr_b16 a[202:203], v26 offset:6656
    s_waitcnt lgkmcnt(8)
    v_mfma_f32_32x32x16_bf16 v[176:191], a[176:179], a[56:59], v[176:191]
    buffer_load_dwordx4 v11, s[20:23], s45 offen offset:1024 lds
    v_mfma_f32_32x32x16_bf16 v[192:207], a[180:183], a[56:59], v[192:207]
    ds_read_b64_tr_b16 a[204:205], v27 offset:6144
    ds_read_b64_tr_b16 a[206:207], v27 offset:6656
    ds_read_b64_tr_b16 a[208:209], v26 offset:14336
    s_waitcnt lgkmcnt(9)
    v_mfma_f32_32x32x16_bf16 v[208:223], a[184:187], a[56:59], v[208:223]
    ds_read_b64_tr_b16 a[210:211], v26 offset:14848
    ds_read_b64_tr_b16 a[212:213], v27 offset:14336
    ds_read_b64_tr_b16 a[214:215], v27 offset:14848
    s_waitcnt lgkmcnt(9)
    v_mfma_f32_32x32x16_bf16 v[112:127], a[60:63], a[188:191], v[112:127]
    s_add_u32 m0, s48, 121216
    s_nop 0
    buffer_load_dwordx4 v10, s[24:27], s45 offen lds
    v_mfma_f32_32x32x16_bf16 v[128:143], a[60:63], a[192:195], v[128:143]
    buffer_load_dwordx4 v11, s[24:27], s45 offen offset:1024 lds
    s_add_u32 s64, s64, 1
    s_cmp_eq_u32 s64, 10
    s_cselect_b32 s64, 2, s64
    s_waitcnt lgkmcnt(6)
    v_mfma_f32_32x32x16_bf16 v[144:159], a[60:63], a[196:199], v[144:159]
    s_waitcnt vmcnt(15) lgkmcnt(0)
    s_barrier
    v_mfma_f32_32x32x16_bf16 v[160:175], a[200:203], a[60:63], v[160:175]
    ds_read_b128 a[64:67], v14 offset:16384
    ds_read_b128 a[160:163], v18 offset:10368
    ds_read_b128 a[164:167], v20 offset:15488
    s_waitcnt vmcnt(11)
    s_add_u32 s52, s46, 139136
    v_add_u32 v56, s52, v56
    v_add_u32 v57, s52, v57
    v_add_u32 v58, s52, v58
    v_add_u32 v59, s52, v59
    s_cmp_eq_u32 s99, 2
    s_cbranch_scc1 PJS_7
    ds_read_b64_tr_b16 v[64:65], v56
    ds_read_b64_tr_b16 v[66:67], v56 offset:1024
    ds_read_b64_tr_b16 v[68:69], v57
    ds_read_b64_tr_b16 v[70:71], v57 offset:1024
    ds_read_b64_tr_b16 v[72:73], v58
    ds_read_b64_tr_b16 v[74:75], v58 offset:1024
    ds_read_b64_tr_b16 v[76:77], v59
    ds_read_b64_tr_b16 v[78:79], v59 offset:1024
    s_branch PJE_8
PJS_7:
    ds_read_b128 v[64:67], v56
    ds_read_b128 v[68:71], v57
    ds_read_b128 v[72:75], v58
    ds_read_b128 v[76:79], v59
    ds_read_b32 v80, v56
    ds_read_b32 v81, v56
    ds_read_b32 v82, v56
    ds_read_b32 v83, v56
PJE_8:
    v_mfma_f32_32x32x16_bf16 v[176:191], a[204:207], a[60:63], v[176:191]
    ds_read_b128 a[168:171], v22 offset:10368
    ds_read_b64_tr_b16 a[172:173], v26 offset:16384
    ds_read_b64_tr_b16 a[174:175], v26 offset:16896
    v_mfma_f32_32x32x16_bf16 v[192:207], a[208:211], a[60:63], v[192:207]
    ds_read_b64_tr_b16 a[176:177], v27 offset:16384
    ds_read_b64_tr_b16 a[178:179], v27 offset:16896
    ds_read_b64_tr_b16 a[180:181], v26 offset:24576
    v_mfma_f32_32x32x16_bf16 v[208:223], a[212:215], a[60:63], v[208:223]
    ds_read_b64_tr_b16 a[182:183], v26 offset:25088
    ds_read_b64_tr_b16 a[184:185], v27 offset:24576
    ds_read_b64_tr_b16 a[186:187], v27 offset:25088
    s_waitcnt lgkmcnt(15)
    v_mfma_f32_32x32x16_bf16 v[112:127], a[64:67], a[160:163], v[112:127]
    s_add_u32 m0, s46, 0
    s_lshl_b32 s43, s64, 7
    buffer_load_dwordx4 v2, s[8:11], s43 offen lds
    v_mfma_f32_32x32x16_bf16 v[128:143], a[64:67], a[164:167], v[128:143]
    ds_read_b128 a[68:71], v15 offset:16384
    ds_read_b128 a[188:191], v19 offset:10368
    ds_read_b128 a[192:195], v21 offset:15488
    s_waitcnt lgkmcnt(12)
    v_lshlrev_b32 v60, 4, v1
    s_waitcnt lgkmcnt(9)
    v_mfma_f32_32x32x16_bf16 v[144:159], a[64:67], a[168:171], v[144:159]
    buffer_load_dwordx4 v3, s[8:11], s43 offen offset:1024 lds
    s_lshl_b32 s52, s101, 2
    s_add_u32 s52, s52, 0
    s_add_u32 s53, s100, 0
    s_cmp_eq_u32 s99, 2
    s_cselect_b32 s52, s101, s52
    s_cselect_b32 s53, s53, s100
    v_mfma_f32_32x32x16_bf16 v[160:175], a[172:175], a[64:67], v[160:175]
    ds_read_b128 a[196:199], v23 offset:10368
    ds_read_b64_tr_b16 a[200:201], v26 offset:18432
    ds_read_b64_tr_b16 a[202:203], v26 offset:18944
    s_mul_i32 s54, s52, 52429
    s_lshr_b32 s54, s54, 18
    s_mul_i32 s55, s54, 5
    s_sub_u32 s55, s52, s55
    s_waitcnt lgkmcnt(8)
    v_mfma_f32_32x32x16_bf16 v[176:191], a[176:179], a[64:67], v[176:191]
    buffer_load_dwordx4 v4, s[8:11], s43 offen offset:2048 lds
    s_mul_i32 s54, s54, 88
    s_add_u32 s54, s54, s53
    s_mul_i32 s54, s54, 5
    s_add_u32 s54, s54, s55
    v_mfma_f32_32x32x16_bf16 v[192:207], a[180:183], a[64:67], v[192:207]
    ds_read_b64_tr_b16 a[204:205], v27 offset:18432
    ds_read_b64_tr_b16 a[206:207], v27 offset:18944
    ds_read_b64_tr_b16 a[208:209], v26 offset:26624
    s_lshl_b32 s54, s54, 10
    s_add_u32 s54, s54, 11534336
    s_cmp_eq_u32 s99, 0
    s_cselect_b32 s54, 0x7ff00000, s54
    buffer_store_dwordx4 v[64:67], v60, s[28:31], s54 offen sc1
    s_waitcnt lgkmcnt(9)
    v_mfma_f32_32x32x16_bf16 v[208:223], a[184:187], a[64:67], v[208:223]
    ds_read_b64_tr_b16 a[210:211], v26 offset:27136
    ds_read_b64_tr_b16 a[212:213], v27 offset:26624
    ds_read_b64_tr_b16 a[214:215], v27 offset:27136
    s_waitcnt lgkmcnt(9)
    v_mfma_f32_32x32x16_bf16 v[112:127], a[68:71], a[188:191], v[112:127]
    buffer_load_dwordx4 v5, s[8:11], s43 offen offset:3072 lds
    v_mfma_f32_32x32x16_bf16 v[128:143], a[68:71], a[192:195], v[128:143]
    ds_read_b128 a[72:75], v16 offset:16384
    ds_read_b128 a[160:163], v20 offset:10368
    ds_read_b128 a[164:167], v18 offset:15488
    s_lshl_b32 s52, s101, 2
    s_add_u32 s52, s52, 1
    s_add_u32 s53, s100, 2
    s_cmp_eq_u32 s99, 2
    s_cselect_b32 s52, s101, s52
    s_cselect_b32 s53, s53, s100
    s_waitcnt lgkmcnt(9)
    v_mfma_f32_32x32x16_bf16 v[144:159], a[68:71], a[196:199], v[144:159]
    s_add_u32 m0, s47, 49152
    s_nop 0
    buffer_load_dwordx4 v6, s[12:15], s43 offen lds
    v_mfma_f32_32x32x16_bf16 v[160:175], a[200:203], a[68:71], v[160:175]
    ds_read_b128 a[168:171], v24 offset:10368
    ds_read_b64_tr_b16 a[172:173], v26 offset:20480
    ds_read_b64_tr_b16 a[174:175], v26 offset:20992
    s_mul_i32 s54, s52, 52429
    s_lshr_b32 s54, s54, 18
    s_mul_i32 s55, s54, 5
    s_sub_u32 s55, s52, s55
    s_waitcnt lgkmcnt(8)
    v_mfma_f32_32x32x16_bf16 v[176:191], a[204:207], a[68:71], v[176:191]
    buffer_load_dwordx4 v7, s[12:15], s43 offen offset:1024 lds
    s_mul_i32 s54, s54, 88
    s_add_u32 s54, s54, s53
    s_mul_i32 s54, s54, 5
    s_add_u32 s54, s54, s55
    v_mfma_f32_32x32x16_bf16 v[192:207], a[208:211], a[68:71], v[192:207]
    ds_read_b64_tr_b16 a[176:177], v27 offset:20480
    ds_read_b64_tr_b16 a[178:179], v27 offset:20992
    ds_read_b64_tr_b16 a[180:181], v26 offset:28672
    s_lshl_b32 s54, s54, 10
    s_add_u32 s54, s54, 11534336
    s_cmp_eq_u32 s99, 0
    s_cselect_b32 s54, 0x7ff00000, s54
    buffer_store_dwordx4 v[68:71], v60, s[28:31], s54 offen sc1
    s_waitcnt lgkmcnt(9)
    v_mfma_f32_32x32x16_bf16 v[208:223], a[212:215], a[68:71], v[208:223]
    ds_read_b64_tr_b16 a[182:183], v26 offset:29184
    ds_read_b64_tr_b16 a[184:185], v27 offset:28672
    ds_read_b64_tr_b16 a[186:187], v27 offset:29184
    s_waitcnt lgkmcnt(9)
    v_mfma_f32_32x32x16_bf16 v[112:127], a[72:75], a[160:163], v[112:127]
    s_mov_b32 exec_hi, 0
    buffer_load_dwordx4 v8, s[12:15], s43 offen offset:2048 lds
    s_mov_b32 exec_hi, -1
    v_mfma_f32_32x32x16_bf16 v[128:143], a[72:75], a[164:167], v[128:143]
    ds_read_b128 a[76:79], v17 offset:16384
    ds_read_b128 a[188:191], v21 offset:10368
    ds_read_b128 a[192:195], v19 offset:15488
    s_lshl_b32 s52, s101, 2
    s_add_u32 s52, s52, 2
    s_add_u32 s53, s100, 4
    s_cmp_eq_u32 s99, 2
    s_cselect_b32 s52, s101, s52
    s_cselect_b32 s53, s53, s100
    s_waitcnt lgkmcnt(9)
    v_mfma_f32_32x32x16_bf16 v[144:159], a[72:75], a[168:171], v[144:159]
    s_add_u32 m0, s48, 80256
    s_mul_i32 s45, s64, 196608
    buffer_load_dwordx4 v10, s[20:23], s45 offen lds
    v_mfma_f32_32x32x16_bf16 v[160:175], a[172:175], a[72:75], v[160:175]
    ds_read_b128 a[196:199], v25 offset:10368
    ds_read_b64_tr_b16 a[200:201], v26 offset:22528
    ds_read_b64_tr_b16 a[202:203], v26 offset:23040
    s_mul_i32 s54, s52, 52429
    s_lshr_b32 s54, s54, 18
    s_mul_i32 s55, s54, 5
    s_sub_u32 s55, s52, s55
    s_waitcnt lgkmcnt(8)
    v_mfma_f32_32x32x16_bf16 v[176:191], a[176:179], a[72:75], v[176:191]
    buffer_load_dwordx4 v11, s[20:23], s45 offen offset:1024 lds
    s_mul_i32 s54, s54, 88
    s_add_u32 s54, s54, s53
    s_mul_i32 s54, s54, 5
    s_add_u32 s54, s54, s55
    v_mfma_f32_32x32x16_bf16 v[192:207], a[180:183], a[72:75], v[192:207]
    ds_read_b64_tr_b16 a[204:205], v27 offset:22528
    ds_read_b64_tr_b16 a[206:207], v27 offset:23040
    ds_read_b64_tr_b16 a[208:209], v26 offset:30720
    s_lshl_b32 s54, s54, 10
    s_add_u32 s54, s54, 11534336
    s_cmp_eq_u32 s99, 0
    s_cselect_b32 s54, 0x7ff00000, s54
    buffer_store_dwordx4 v[72:75], v60, s[28:31], s54 offen sc1
    s_waitcnt lgkmcnt(9)
    v_mfma_f32_32x32x16_bf16 v[208:223], a[184:187], a[72:75], v[208:223]
    ds_read_b64_tr_b16 a[210:211], v26 offset:31232
    ds_read_b64_tr_b16 a[212:213], v27 offset:30720
    ds_read_b64_tr_b16 a[214:215], v27 offset:31232
    s_waitcnt lgkmcnt(9)
    v_mfma_f32_32x32x16_bf16 v[112:127], a[76:79], a[188:191], v[112:127]
    s_add_u32 m0, s48, 88448
    s_nop 0
    buffer_load_dwordx4 v10, s[24:27], s45 offen lds
    v_mfma_f32_32x32x16_bf16 v[128:143], a[76:79], a[192:195], v[128:143]
    buffer_load_dwordx4 v11, s[24:27], s45 offen offset:1024 lds
    s_add_u32 s64, s64, 1
    s_cmp_eq_u32 s64, 10
    s_cselect_b32 s64, 2, s64
    s_waitcnt lgkmcnt(6)
    v_mfma_f32_32x32x16_bf16 v[144:159], a[76:79], a[196:199], v[144:159]
    s_waitcnt vmcnt(14) lgkmcnt(0)
    s_barrier
    v_mfma_f32_32x32x16_bf16 v[160:175], a[200:203], a[76:79], v[160:175]
    ds_read_b128 a[80:83], v14 offset:32768
    ds_read_b128 a[160:163], v18 offset:20736
    ds_read_b128 a[164:167], v20 offset:25856
    s_lshl_b32 s52, s101, 2
    s_add_u32 s52, s52, 3
    s_add_u32 s53, s100, 6
    s_cmp_eq_u32 s99, 2
    s_cselect_b32 s52, s101, s52
    s_cselect_b32 s53, s53, s100
    v_mfma_f32_32x32x16_bf16 v[176:191], a[204:207], a[76:79], v[176:191]
    ds_read_b128 a[168:171], v22 offset:20736
    ds_read_b64_tr_b16 a[172:173], v26 offset:32768
    ds_read_b64_tr_b16 a[174:175], v26 offset:33280
    s_mul_i32 s54, s52, 52429
    s_lshr_b32 s54, s54, 18
    s_mul_i32 s55, s54, 5
    s_sub_u32 s55, s52, s55
    v_mfma_f32_32x32x16_bf16 v[192:207], a[208:211], a[76:79], v[192:207]
    ds_read_b64_tr_b16 a[176:177], v27 offset:32768
    ds_read_b64_tr_b16 a[178:179], v27 offset:33280
    ds_read_b64_tr_b16 a[180:181], v26 offset:40960
    s_mul_i32 s54, s54, 88
    s_add_u32 s54, s54, s53
    s_mul_i32 s54, s54, 5
    s_add_u32 s54, s54, s55
    v_mfma_f32_32x32x16_bf16 v[208:223], a[212:215], a[76:79], v[208:223]
    ds_read_b64_tr_b16 a[182:183], v26 offset:41472
    ds_read_b64_tr_b16 a[184:185], v27 offset:40960
    ds_read_b64_tr_b16 a[186:187], v27 offset:41472
    s_lshl_b32 s54, s54, 10
    s_add_u32 s54, s54, 11534336
    s_cmp_eq_u32 s99, 0
    s_cselect_b32 s54, 0x7ff00000, s54
    buffer_store_dwordx4 v[76:79], v60, s[28:31], s54 offen sc1
    s_waitcnt lgkmcnt(9)
    v_mfma_f32_32x32x16_bf16 v[112:127], a[80:83], a[160:163], v[112:127]
    s_add_u32 m0, s46, 16384
    s_lshl_b32 s43, s64, 7
    buffer_load_dwordx4 v2, s[8:11], s43 offen lds
    v_mfma_f32_32x32x16_bf16 v[128:143], a[80:83], a[164:167], v[128:143]
    ds_read_b128 a[84:87], v15 offset:32768
    ds_read_b128 a[188:191], v19 offset:20736
    ds_read_b128 a[192:195], v21 offset:25856
    s_mov_b32 s60, 40000
NP_9:
    v_readfirstlane_b32 s50, v30
    s_nop 3
    s_cmp_lg_u32 s50, 0
    s_cbranch_scc1 NPD_10
    s_sub_u32 s60, s60, 1
    s_cmp_eq_u32 s60, 0
    s_cbranch_scc1 NPD_10
    s_sleep 2
    buffer_load_dword v30, off, s[36:39], 0 sc0 sc1
    s_waitcnt vmcnt(0)
    s_branch NP_9
NPD_10:
    s_waitcnt lgkmcnt(9)
    v_mfma_f32_32x32x16_bf16 v[144:159], a[80:83], a[168:171], v[144:159]
    buffer_load_dwordx4 v3, s[8:11], s43 offen offset:1024 lds
    v_accvgpr_write_b32 a255, s50
    s_cmp_eq_u32 s84, 0x7ff00000
    s_cselect_b32 s88, 0, s50
    v_mfma_f32_32x32x16_bf16 v[160:175], a[172:175], a[80:83], v[160:175]
    ds_read_b128 a[196:199], v23 offset:20736
    ds_read_b64_tr_b16 a[200:201], v26 offset:34816
    ds_read_b64_tr_b16 a[202:203], v26 offset:35328
    s_cmp_eq_u32 s85, 0x7ff00000
    s_cselect_b32 s89, 0, s50
    s_waitcnt lgkmcnt(8)
    v_mfma_f32_32x32x16_bf16 v[176:191], a[176:179], a[80:83], v[176:191]
    buffer_load_dwordx4 v4, s[8:11], s43 offen offset:2048 lds
    s_cmp_eq_u32 s86, 0x7ff00000
    s_cselect_b32 s94, 0, s50
    v_mfma_f32_32x32x16_bf16 v[192:207], a[180:183], a[80:83], v[192:207]
    ds_read_b64_tr_b16 a[204:205], v27 offset:34816
    ds_read_b64_tr_b16 a[206:207], v27 offset:35328
    ds_read_b64_tr_b16 a[208:209], v26 offset:43008
    s_cmp_eq_u32 s87, 0x7ff00000
    s_cselect_b32 s95, 0, s50
    s_waitcnt lgkmcnt(9)
    v_mfma_f32_32x32x16_bf16 v[208:223], a[184:187], a[80:83], v[208:223]
    ds_read_b64_tr_b16 a[210:211], v26 offset:43520
    ds_read_b64_tr_b16 a[212:213], v27 offset:43008
    ds_read_b64_tr_b16 a[214:215], v27 offset:43520
    s_waitcnt lgkmcnt(9)
    v_mfma_f32_32x32x16_bf16 v[112:127], a[84:87], a[188:191], v[112:127]
    buffer_load_dwordx4 v5, s[8:11], s43 offen offset:3072 lds
    v_mfma_f32_32x32x16_bf16 v[128:143], a[84:87], a[192:195], v[128:143]
    ds_read_b128 a[88:91], v16 offset:32768
    ds_read_b128 a[160:163], v20 offset:20736
    ds_read_b128 a[164:167], v18 offset:25856
    s_waitcnt lgkmcnt(9)
    v_mfma_f32_32x32x16_bf16 v[144:159], a[84:87], a[196:199], v[144:159]
    s_add_u32 m0, s47, 59520
    s_nop 0
    buffer_load_dwordx4 v6, s[12:15], s43 offen lds
    v_mfma_f32_32x32x16_bf16 v[160:175], a[200:203], a[84:87], v[160:175]
    ds_read_b128 a[168:171], v24 offset:20736
    ds_read_b64_tr_b16 a[172:173], v26 offset:36864
    ds_read_b64_tr_b16 a[174:175], v26 offset:37376
    s_waitcnt lgkmcnt(8)
    v_mfma_f32_32x32x16_bf16 v[176:191], a[204:207], a[84:87], v[176:191]
    buffer_load_dwordx4 v7, s[12:15], s43 offen offset:1024 lds
    v_mfma_f32_32x32x16_bf16 v[192:207], a[208:211], a[84:87], v[192:207]
    ds_read_b64_tr_b16 a[176:177], v27 offset:36864
    ds_read_b64_tr_b16 a[178:179], v27 offset:37376
    ds_read_b64_tr_b16 a[180:181], v26 offset:45056
    s_waitcnt lgkmcnt(9)
    v_mfma_f32_32x32x16_bf16 v[208:223], a[212:215], a[84:87], v[208:223]
    ds_read_b64_tr_b16 a[182:183], v26 offset:45568
    ds_read_b64_tr_b16 a[184:185], v27 offset:45056
    ds_read_b64_tr_b16 a[186:187], v27 offset:45568
    s_waitcnt lgkmcnt(9)
    v_mfma_f32_32x32x16_bf16 v[112:127], a[88:91], a[160:163], v[112:127]
    s_mov_b32 exec_hi, 0
    buffer_load_dwordx4 v8, s[12:15], s43 offen offset:2048 lds
    s_mov_b32 exec_hi, -1
    v_mfma_f32_32x32x16_bf16 v[128:143], a[88:91], a[164:167], v[128:143]
    ds_read_b128 a[92:95], v17 offset:32768
    ds_read_b128 a[188:191], v21 offset:20736
    ds_read_b128 a[192:195], v19 offset:25856
    s_waitcnt lgkmcnt(9)
    v_mfma_f32_32x32x16_bf16 v[144:159], a[88:91], a[168:171], v[144:159]
    s_add_u32 m0, s48, 96640
    s_mul_i32 s45, s64, 196608
    buffer_load_dwordx4 v10, s[20:23], s45 offen lds
    v_mfma_f32_32x32x16_bf16 v[160:175], a[172:175], a[88:91], v[160:175]
    ds_read_b128 a[196:199], v25 offset:20736
    ds_read_b64_tr_b16 a[200:201], v26 offset:38912
    ds_read_b64_tr_b16 a[202:203], v26 offset:39424
    s_waitcnt lgkmcnt(8)
    v_mfma_f32_32x32x16_bf16 v[176:191], a[176:179], a[88:91], v[176:191]
    buffer_load_dwordx4 v11, s[20:23], s45 offen offset:1024 lds
    v_mfma_f32_32x32x16_bf16 v[192:207], a[180:183], a[88:91], v[192:207]
    ds_read_b64_tr_b16 a[204:205], v27 offset:38912
    ds_read_b64_tr_b16 a[206:207], v27 offset:39424
    ds_read_b64_tr_b16 a[208:209], v26 offset:47104
    s_waitcnt lgkmcnt(9)
    v_mfma_f32_32x32x16_bf16 v[208:223], a[184:187], a[88:91], v[208:223]
    ds_read_b64_tr_b16 a[210:211], v26 offset:47616
    ds_read_b64_tr_b16 a[212:213], v27 offset:47104
    ds_read_b64_tr_b16 a[214:215], v27 offset:47616
    s_waitcnt lgkmcnt(9)
    v_mfma_f32_32x32x16_bf16 v[112:127], a[92:95], a[188:191], v[112:127]
    s_add_u32 m0, s48, 104832
    s_nop 0
    buffer_load_dwordx4 v10, s[24:27], s45 offen lds
    v_mfma_f32_32x32x16_bf16 v[128:143], a[92:95], a[192:195], v[128:143]
    buffer_load_dwordx4 v11, s[24:27], s45 offen offset:1024 lds
    s_add_u32 s64, s64, 1
    s_cmp_eq_u32 s64, 10
    s_cselect_b32 s64, 2, s64
    s_waitcnt lgkmcnt(6)
    v_mfma_f32_32x32x16_bf16 v[144:159], a[92:95], a[196:199], v[144:159]
    s_waitcnt vmcnt(12) lgkmcnt(0)
    s_barrier
    v_mfma_f32_32x32x16_bf16 v[160:175], a[200:203], a[92:95], v[160:175]
    ds_read_b128 a[96:99], v14 offset:0
    ds_read_b128 a[160:163], v18 offset:0
    ds_read_b128 a[164:167], v20 offset:5120
    v_mfma_f32_32x32x16_bf16 v[176:191], a[204:207], a[92:95], v[176:191]
    ds_read_b128 a[168:171], v22 offset:0
    ds_read_b64_tr_b16 a[172:173], v26 offset:0
    ds_read_b64_tr_b16 a[174:175], v26 offset:512
    v_mfma_f32_32x32x16_bf16 v[192:207], a[208:211], a[92:95], v[192:207]
    ds_read_b64_tr_b16 a[176:177], v27 offset:0
    ds_read_b64_tr_b16 a[178:179], v27 offset:512
    ds_read_b64_tr_b16 a[180:181], v26 offset:8192
    v_mfma_f32_32x32x16_bf16 v[208:223], a[212:215], a[92:95], v[208:223]
    ds_read_b64_tr_b16 a[182:183], v26 offset:8704
    ds_read_b64_tr_b16 a[184:185], v27 offset:8192
    ds_read_b64_tr_b16 a[186:187], v27 offset:8704
    s_waitcnt lgkmcnt(9)
    v_mfma_f32_32x32x16_bf16 v[112:127], a[96:99], a[160:163], v[112:127]
    s_add_u32 m0, s46, 32768
    s_lshl_b32 s43, s64, 7
    buffer_load_dwordx4 v2, s[8:11], s43 offen lds
    v_mfma_f32_32x32x16_bf16 v[128:143], a[96:99], a[164:167], v[128:143]
    ds_read_b128 a[100:103], v15 offset:0
    ds_read_b128 a[188:191], v19 offset:0
    ds_read_b128 a[192:195], v21 offset:5120
    s_waitcnt lgkmcnt(9)
    v_mfma_f32_32x32x16_bf16 v[144:159], a[96:99], a[168:171], v[144:159]
    buffer_load_dwordx4 v3, s[8:11], s43 offen offset:1024 lds
    v_mfma_f32_32x32x16_bf16 v[160:175], a[172:175], a[96:99], v[160:175]
    ds_read_b128 a[196:199], v23 offset:0
    ds_read_b64_tr_b16 a[200:201], v26 offset:2048
    ds_read_b64_tr_b16 a[202:203], v26 offset:2560
    s_waitcnt lgkmcnt(8)
    v_mfma_f32_32x32x16_bf16 v[176:191], a[176:179], a[96:99], v[176:191]
    buffer_load_dwordx4 v4, s[8:11], s43 offen offset:2048 lds
    v_mfma_f32_32x32x16_bf16 v[192:207], a[180:183], a[96:99], v[192:207]
    ds_read_b64_tr_b16 a[204:205], v27 offset:2048
    ds_read_b64_tr_b16 a[206:207], v27 offset:2560
    ds_read_b64_tr_b16 a[208:209], v26 offset:10240
    s_waitcnt lgkmcnt(9)
    v_mfma_f32_32x32x16_bf16 v[208:223], a[184:187], a[96:99], v[208:223]
    ds_read_b64_tr_b16 a[210:211], v26 offset:10752
    ds_read_b64_tr_b16 a[212:213], v27 offset:10240
    ds_read_b64_tr_b16 a[214:215], v27 offset:10752
    s_waitcnt lgkmcnt(9)
    v_mfma_f32_32x32x16_bf16 v[112:127], a[100:103], a[188:191], v[112:127]
    buffer_load_dwordx4 v5, s[8:11], s43 offen offset:3072 lds
    v_mfma_f32_32x32x16_bf16 v[128:143], a[100:103], a[192:195], v[128:143]
    ds_read_b128 a[104:107], v16 offset:0
    ds_read_b128 a[160:163], v20 offset:0
    ds_read_b128 a[164:167], v18 offset:5120
    s_waitcnt lgkmcnt(9)
    v_mfma_f32_32x32x16_bf16 v[144:159], a[100:103], a[196:199], v[144:159]
    s_add_u32 m0, s47, 69888
    s_nop 0
    buffer_load_dwordx4 v6, s[12:15], s43 offen lds
    v_mfma_f32_32x32x16_bf16 v[160:175], a[200:203], a[100:103], v[160:175]
    ds_read_b128 a[168:171], v24 offset:0
    ds_read_b64_tr_b16 a[172:173], v26 offset:4096
    ds_read_b64_tr_b16 a[174:175], v26 offset:4608
    s_waitcnt lgkmcnt(8)
    v_mfma_f32_32x32x16_bf16 v[176:191], a[204:207], a[100:103], v[176:191]
    buffer_load_dwordx4 v7, s[12:15], s43 offen offset:1024 lds
    v_mfma_f32_32x32x16_bf16 v[192:207], a[208:211], a[100:103], v[192:207]
    ds_read_b64_tr_b16 a[176:177], v27 offset:4096
    ds_read_b64_tr_b16 a[178:179], v27 offset:4608
    ds_read_b64_tr_b16 a[180:181], v26 offset:12288
    s_waitcnt lgkmcnt(9)
    v_mfma_f32_32x32x16_bf16 v[208:223], a[212:215], a[100:103], v[208:223]
    ds_read_b64_tr_b16 a[182:183], v26 offset:12800
    ds_read_b64_tr_b16 a[184:185], v27 offset:12288
    ds_read_b64_tr_b16 a[186:187], v27 offset:12800
    s_waitcnt lgkmcnt(9)
    v_mfma_f32_32x32x16_bf16 v[112:127], a[104:107], a[160:163], v[112:127]
    s_mov_b32 exec_hi, 0
    buffer_load_dwordx4 v8, s[12:15], s43 offen offset:2048 lds
    s_mov_b32 exec_hi, -1
    v_mfma_f32_32x32x16_bf16 v[128:143], a[104:107], a[164:167], v[128:143]
    ds_read_b128 a[108:111], v17 offset:0
    ds_read_b128 a[188:191], v21 offset:0
    ds_read_b128 a[192:195], v19 offset:5120
    s_waitcnt lgkmcnt(9)
    v_mfma_f32_32x32x16_bf16 v[144:159], a[104:107], a[168:171], v[144:159]
    s_add_u32 m0, s48, 113024
    s_mul_i32 s45, s64, 196608
    buffer_load_dwordx4 v10, s[20:23], s45 offen lds
    v_mfma_f32_32x32x16_bf16 v[160:175], a[172:175], a[104:107], v[160:175]
    ds_read_b128 a[196:199], v25 offset:0
    ds_read_b64_tr_b16 a[200:201], v26 offset:6144
    ds_read_b64_tr_b16 a[202:203], v26 offset:6656
    s_waitcnt lgkmcnt(8)
    v_mfma_f32_32x32x16_bf16 v[176:191], a[176:179], a[104:107], v[176:191]
    buffer_load_dwordx4 v11, s[20:23], s45 offen offset:1024 lds
    v_mfma_f32_32x32x16_bf16 v[192:207], a[180:183], a[104:107], v[192:207]
    ds_read_b64_tr_b16 a[204:205], v27 offset:6144
    ds_read_b64_tr_b16 a[206:207], v27 offset:6656
    ds_read_b64_tr_b16 a[208:209], v26 offset:14336
    s_waitcnt lgkmcnt(9)
    v_mfma_f32_32x32x16_bf16 v[208:223], a[184:187], a[104:107], v[208:223]
    ds_read_b64_tr_b16 a[210:211], v26 offset:14848
    ds_read_b64_tr_b16 a[212:213], v27 offset:14336
    ds_read_b64_tr_b16 a[214:215], v27 offset:14848
    s_waitcnt lgkmcnt(9)
    v_mfma_f32_32x32x16_bf16 v[112:127], a[108:111], a[188:191], v[112:127]
    s_add_u32 m0, s48, 121216
    s_nop 0
    buffer_load_dwordx4 v10, s[24:27], s45 offen lds
    v_mfma_f32_32x32x16_bf16 v[128:143], a[108:111], a[192:195], v[128:143]
    buffer_load_dwordx4 v11, s[24:27], s45 offen offset:1024 lds
    s_add_u32 s64, s64, 1
    s_cmp_eq_u32 s64, 10
    s_cselect_b32 s64, 2, s64
    s_waitcnt lgkmcnt(6)
    v_mfma_f32_32x32x16_bf16 v[144:159], a[108:111], a[196:199], v[144:159]
    s_waitcnt vmcnt(11) lgkmcnt(0)
    s_barrier
    s_mov_b64 exec, 1
    buffer_store_dword a255, off, s[28:31], s73 sc0 sc1
    s_mov_b64 exec, -1
    v_mfma_f32_32x32x16_bf16 v[160:175], a[200:203], a[108:111], v[160:175]
    ds_read_b128 a[112:115], v14 offset:16384
    ds_read_b128 a[160:163], v18 offset:10368
    ds_read_b128 a[164:167], v20 offset:15488
    v_mfma_f32_32x32x16_bf16 v[176:191], a[204:207], a[108:111], v[176:191]
    ds_read_b128 a[168:171], v22 offset:10368
    ds_read_b64_tr_b16 a[172:173], v26 offset:16384
    ds_read_b64_tr_b16 a[174:175], v26 offset:16896
    v_mfma_f32_32x32x16_bf16 v[192:207], a[208:211], a[108:111], v[192:207]
    ds_read_b64_tr_b16 a[176:177], v27 offset:16384
    ds_read_b64_tr_b16 a[178:179], v27 offset:16896
    ds_read_b64_tr_b16 a[180:181], v26 offset:24576
    v_mfma_f32_32x32x16_bf16 v[208:223], a[212:215], a[108:111], v[208:223]
    ds_read_b64_tr_b16 a[182:183], v26 offset:25088
    ds_read_b64_tr_b16 a[184:185], v27 offset:24576
    ds_read_b64_tr_b16 a[186:187], v27 offset:25088
    s_waitcnt lgkmcnt(9)
    v_mfma_f32_32x32x16_bf16 v[112:127], a[112:115], a[160:163], v[112:127]
    s_add_u32 m0, s46, 0
    s_lshl_b32 s43, s64, 7
    buffer_load_dwordx4 v2, s[8:11], s43 offen lds
    v_mfma_f32_32x32x16_bf16 v[128:143], a[112:115], a[164:167], v[128:143]
    ds_read_b128 a[116:119], v15 offset:16384
    ds_read_b128 a[188:191], v19 offset:10368
    ds_read_b128 a[192:195], v21 offset:15488
    s_waitcnt lgkmcnt(9)
    v_mfma_f32_32x32x16_bf16 v[144:159], a[112:115], a[168:171], v[144:159]
    buffer_load_dwordx4 v3, s[8:11], s43 offen offset:1024 lds
    v_mfma_f32_32x32x16_bf16 v[160:175], a[172:175], a[112:115], v[160:175]
    ds_read_b128 a[196:199], v23 offset:10368
    ds_read_b64_tr_b16 a[200:201], v26 offset:18432
    ds_read_b64_tr_b16 a[202:203], v26 offset:18944
    s_waitcnt lgkmcnt(8)
    v_mfma_f32_32x32x16_bf16 v[176:191], a[176:179], a[112:115], v[176:191]
    buffer_load_dwordx4 v4, s[8:11], s43 offen offset:2048 lds
    v_mfma_f32_32x32x16_bf16 v[192:207], a[180:183], a[112:115], v[192:207]
    ds_read_b64_tr_b16 a[204:205], v27 offset:18432
    ds_read_b64_tr_b16 a[206:207], v27 offset:18944
    ds_read_b64_tr_b16 a[208:209], v26 offset:26624
    s_waitcnt lgkmcnt(9)
    v_mfma_f32_32x32x16_bf16 v[208:223], a[184:187], a[112:115], v[208:223]
    ds_read_b64_tr_b16 a[210:211], v26 offset:27136
    ds_read_b64_tr_b16 a[212:213], v27 offset:26624
    ds_read_b64_tr_b16 a[214:215], v27 offset:27136
    s_waitcnt lgkmcnt(9)
    v_mfma_f32_32x32x16_bf16 v[112:127], a[116:119], a[188:191], v[112:127]
    buffer_load_dwordx4 v5, s[8:11], s43 offen offset:3072 lds
    v_mfma_f32_32x32x16_bf16 v[128:143], a[116:119], a[192:195], v[128:143]
    ds_read_b128 a[120:123], v16 offset:16384
    ds_read_b128 a[160:163], v20 offset:10368
    ds_read_b128 a[164:167], v18 offset:15488
    s_waitcnt lgkmcnt(9)
    v_mfma_f32_32x32x16_bf16 v[144:159], a[116:119], a[196:199], v[144:159]
    s_add_u32 m0, s47, 49152
    s_nop 0
    buffer_load_dwordx4 v6, s[12:15], s43 offen lds
    v_mfma_f32_32x32x16_bf16 v[160:175], a[200:203], a[116:119], v[160:175]
    ds_read_b128 a[168:171], v24 offset:10368
    ds_read_b64_tr_b16 a[172:173], v26 offset:20480
    ds_read_b64_tr_b16 a[174:175], v26 offset:20992
    s_waitcnt lgkmcnt(8)
    v_mfma_f32_32x32x16_bf16 v[176:191], a[204:207], a[116:119], v[176:191]
    buffer_load_dwordx4 v7, s[12:15], s43 offen offset:1024 lds
    v_mfma_f32_32x32x16_bf16 v[192:207], a[208:211], a[116:119], v[192:207]
    ds_read_b64_tr_b16 a[176:177], v27 offset:20480
    ds_read_b64_tr_b16 a[178:179], v27 offset:20992
    ds_read_b64_tr_b16 a[180:181], v26 offset:28672
    s_waitcnt lgkmcnt(9)
    v_mfma_f32_32x32x16_bf16 v[208:223], a[212:215], a[116:119], v[208:223]
    ds_read_b64_tr_b16 a[182:183], v26 offset:29184
    ds_read_b64_tr_b16 a[184:185], v27 offset:28672
    ds_read_b64_tr_b16 a[186:187], v27 offset:29184
    s_waitcnt lgkmcnt(9)
    v_mfma_f32_32x32x16_bf16 v[112:127], a[120:123], a[160:163], v[112:127]
    s_mov_b32 exec_hi, 0
    buffer_load_dwordx4 v8, s[12:15], s43 offen offset:2048 lds
    s_mov_b32 exec_hi, -1
    v_mfma_f32_32x32x16_bf16 v[128:143], a[120:123], a[164:167], v[128:143]
    ds_read_b128 a[124:127], v17 offset:16384
    ds_read_b128 a[188:191], v21 offset:10368
    ds_read_b128 a[192:195], v19 offset:15488
    s_waitcnt lgkmcnt(9)
    v_mfma_f32_32x32x16_bf16 v[144:159], a[120:123], a[168:171], v[144:159]
    s_add_u32 m0, s48, 80256
    s_mul_i32 s45, s64, 196608
    buffer_load_dwordx4 v10, s[20:23], s45 offen lds
    v_mfma_f32_32x32x16_bf16 v[160:175], a[172:175], a[120:123], v[160:175]
    ds_read_b128 a[196:199], v25 offset:10368
    ds_read_b64_tr_b16 a[200:201], v26 offset:22528
    ds_read_b64_tr_b16 a[202:203], v26 offset:23040
    s_waitcnt lgkmcnt(8)
    v_mfma_f32_32x32x16_bf16 v[176:191], a[176:179], a[120:123], v[176:191]
    buffer_load_dwordx4 v11, s[20:23], s45 offen offset:1024 lds
    v_mfma_f32_32x32x16_bf16 v[192:207], a[180:183], a[120:123], v[192:207]
    ds_read_b64_tr_b16 a[204:205], v27 offset:22528
    ds_read_b64_tr_b16 a[206:207], v27 offset:23040
    ds_read_b64_tr_b16 a[208:209], v26 offset:30720
    s_waitcnt lgkmcnt(9)
    v_mfma_f32_32x32x16_bf16 v[208:223], a[184:187], a[120:123], v[208:223]
    ds_read_b64_tr_b16 a[210:211], v26 offset:31232
    ds_read_b64_tr_b16 a[212:213], v27 offset:30720
    ds_read_b64_tr_b16 a[214:215], v27 offset:31232
    s_waitcnt lgkmcnt(9)
    v_mfma_f32_32x32x16_bf16 v[112:127], a[124:127], a[188:191], v[112:127]
    s_add_u32 m0, s48, 88448
    s_nop 0
    buffer_load_dwordx4 v10, s[24:27], s45 offen lds
    v_mfma_f32_32x32x16_bf16 v[128:143], a[124:127], a[192:195], v[128:143]
    buffer_load_dwordx4 v11, s[24:27], s45 offen offset:1024 lds
    s_add_u32 s64, s64, 1
    s_cmp_eq_u32 s64, 10
    s_cselect_b32 s64, 2, s64
    s_waitcnt lgkmcnt(6)
    v_mfma_f32_32x32x16_bf16 v[144:159], a[124:127], a[196:199], v[144:159]
    s_add_u32 m0, s49, 139136
    s_mul_i32 s45, s65, 196608
    buffer_load_dwordx4 v12, s[20:23], s45 offen lds
    s_add_u32 m0, s49, 143232
    s_nop 0
    buffer_load_dwordx4 v12, s[24:27], s45 offen lds
    s_add_u32 s65, s65, 1
    s_waitcnt vmcnt(14) lgkmcnt(0)
    s_barrier
    v_mfma_f32_32x32x16_bf16 v[160:175], a[200:203], a[124:127], v[160:175]
    ds_read_b128 a[128:131], v14 offset:32768
    ds_read_b128 a[160:163], v18 offset:20736
    ds_read_b128 a[164:167], v20 offset:25856
    v_mfma_f32_32x32x16_bf16 v[176:191], a[204:207], a[124:127], v[176:191]
    ds_read_b128 a[168:171], v22 offset:20736
    ds_read_b64_tr_b16 a[172:173], v26 offset:32768
    ds_read_b64_tr_b16 a[174:175], v26 offset:33280
    v_mfma_f32_32x32x16_bf16 v[192:207], a[208:211], a[124:127], v[192:207]
    ds_read_b64_tr_b16 a[176:177], v27 offset:32768
    ds_read_b64_tr_b16 a[178:179], v27 offset:33280
    ds_read_b64_tr_b16 a[180:181], v26 offset:40960
    v_mfma_f32_32x32x16_bf16 v[208:223], a[212:215], a[124:127], v[208:223]
    ds_read_b64_tr_b16 a[182:183], v26 offset:41472
    ds_read_b64_tr_b16 a[184:185], v27 offset:40960
    ds_read_b64_tr_b16 a[186:187], v27 offset:41472
    s_waitcnt lgkmcnt(9)
    v_mfma_f32_32x32x16_bf16 v[112:127], a[128:131], a[160:163], v[112:127]
    s_add_u32 m0, s49, 147328
    s_mul_i32 s45, s65, 196608
    buffer_load_dwordx4 v12, s[20:23], s45 offen lds
    v_mfma_f32_32x32x16_bf16 v[128:143], a[128:131], a[164:167], v[128:143]
    ds_read_b128 a[132:135], v15 offset:32768
    ds_read_b128 a[188:191], v19 offset:20736
    ds_read_b128 a[192:195], v21 offset:25856
    s_waitcnt lgkmcnt(9)
    v_mfma_f32_32x32x16_bf16 v[144:159], a[128:131], a[168:171], v[144:159]
    s_add_u32 m0, s49, 151424
    s_nop 0
    buffer_load_dwordx4 v12, s[24:27], s45 offen lds
    s_mov_b32 s65, s83
    v_mfma_f32_32x32x16_bf16 v[160:175], a[172:175], a[128:131], v[160:175]
    ds_read_b128 a[196:199], v23 offset:20736
    ds_read_b64_tr_b16 a[200:201], v26 offset:34816
    ds_read_b64_tr_b16 a[202:203], v26 offset:35328
    s_waitcnt lgkmcnt(8)
    v_mfma_f32_32x32x16_bf16 v[176:191], a[176:179], a[128:131], v[176:191]
    s_add_u32 m0, s49, 16384
    s_mul_i32 s45, s65, 196608
    buffer_load_dwordx4 v12, s[20:23], s45 offen lds
    v_mfma_f32_32x32x16_bf16 v[192:207], a[180:183], a[128:131], v[192:207]
    ds_read_b64_tr_b16 a[204:205], v27 offset:34816
    ds_read_b64_tr_b16 a[206:207], v27 offset:35328
    ds_read_b64_tr_b16 a[208:209], v26 offset:43008
    s_waitcnt lgkmcnt(9)
    v_mfma_f32_32x32x16_bf16 v[208:223], a[184:187], a[128:131], v[208:223]
    ds_read_b64_tr_b16 a[210:211], v26 offset:43520
    ds_read_b64_tr_b16 a[212:213], v27 offset:43008
    ds_read_b64_tr_b16 a[214:215], v27 offset:43520
    s_waitcnt lgkmcnt(9)
    v_mfma_f32_32x32x16_bf16 v[112:127], a[132:135], a[188:191], v[112:127]
    s_add_u32 m0, s49, 20480
    s_nop 0
    buffer_load_dwordx4 v12, s[24:27], s45 offen lds
    s_add_u32 s65, s65, 1
    s_cmp_eq_u32 s65, 10
    s_cselect_b32 s65, 2, s65
    v_mfma_f32_32x32x16_bf16 v[128:143], a[132:135], a[192:195], v[128:143]
    ds_read_b128 a[136:139], v16 offset:32768
    ds_read_b128 a[160:163], v20 offset:20736
    ds_read_b128 a[164:167], v18 offset:25856
    s_waitcnt lgkmcnt(9)
    v_mfma_f32_32x32x16_bf16 v[144:159], a[132:135], a[196:199], v[144:159]
    s_add_u32 m0, s49, 24576
    s_mul_i32 s45, s65, 196608
    buffer_load_dwordx4 v12, s[20:23], s45 offen lds
    v_mfma_f32_32x32x16_bf16 v[160:175], a[200:203], a[132:135], v[160:175]
    ds_read_b128 a[168:171], v24 offset:20736
    ds_read_b64_tr_b16 a[172:173], v26 offset:36864
    ds_read_b64_tr_b16 a[174:175], v26 offset:37376
    s_waitcnt lgkmcnt(8)
    v_mfma_f32_32x32x16_bf16 v[176:191], a[204:207], a[132:135], v[176:191]
    s_add_u32 m0, s49, 28672
    s_nop 0
    buffer_load_dwordx4 v12, s[24:27], s45 offen lds
    s_add_u32 s65, s65, 1
    s_cmp_eq_u32 s65, 10
    s_cselect_b32 s65, 2, s65
    v_mfma_f32_32x32x16_bf16 v[192:207], a[208:211], a[132:135], v[192:207]
    ds_read_b64_tr_b16 a[176:177], v27 offset:36864
    ds_read_b64_tr_b16 a[178:179], v27 offset:37376
    ds_read_b64_tr_b16 a[180:181], v26 offset:45056
    s_waitcnt lgkmcnt(9)
    v_mfma_f32_32x32x16_bf16 v[208:223], a[212:215], a[132:135], v[208:223]
    ds_read_b64_tr_b16 a[182:183], v26 offset:45568
    ds_read_b64_tr_b16 a[184:185], v27 offset:45056
    ds_read_b64_tr_b16 a[186:187], v27 offset:45568
    s_waitcnt lgkmcnt(9)
    v_mfma_f32_32x32x16_bf16 v[112:127], a[136:139], a[160:163], v[112:127]
    s_add_u32 m0, s49, 59520
    s_mul_i32 s45, s65, 196608
    buffer_load_dwordx4 v12, s[20:23], s45 offen lds
    v_mfma_f32_32x32x16_bf16 v[128:143], a[136:139], a[164:167], v[128:143]
    ds_read_b128 a[140:143], v17 offset:32768
    ds_read_b128 a[188:191], v21 offset:20736
    ds_read_b128 a[192:195], v19 offset:25856
    s_waitcnt lgkmcnt(9)
    v_mfma_f32_32x32x16_bf16 v[144:159], a[136:139], a[168:171], v[144:159]
    s_add_u32 m0, s49, 63616
    s_nop 0
    buffer_load_dwordx4 v12, s[24:27], s45 offen lds
    s_add_u32 s65, s65, 1
    s_cmp_eq_u32 s65, 10
    s_cselect_b32 s65, 2, s65
    v_mfma_f32_32x32x16_bf16 v[160:175], a[172:175], a[136:139], v[160:175]
    ds_read_b128 a[196:199], v25 offset:20736
    ds_read_b64_tr_b16 a[200:201], v26 offset:38912
    ds_read_b64_tr_b16 a[202:203], v26 offset:39424
    s_waitcnt lgkmcnt(8)
    v_mfma_f32_32x32x16_bf16 v[176:191], a[176:179], a[136:139], v[176:191]
    v_mfma_f32_32x32x16_bf16 v[192:207], a[180:183], a[136:139], v[192:207]
    ds_read_b64_tr_b16 a[204:205], v27 offset:38912
    ds_read_b64_tr_b16 a[206:207], v27 offset:39424
    ds_read_b64_tr_b16 a[208:209], v26 offset:47104
    s_waitcnt lgkmcnt(9)
    v_mfma_f32_32x32x16_bf16 v[208:223], a[184:187], a[136:139], v[208:223]
    ds_read_b64_tr_b16 a[210:211], v26 offset:47616
    ds_read_b64_tr_b16 a[212:213], v27 offset:47104
    ds_read_b64_tr_b16 a[214:215], v27 offset:47616
    s_waitcnt lgkmcnt(9)
    v_mfma_f32_32x32x16_bf16 v[112:127], a[140:143], a[188:191], v[112:127]
    v_mfma_f32_32x32x16_bf16 v[128:143], a[140:143], a[192:195], v[128:143]
    s_waitcnt lgkmcnt(6)
    v_mfma_f32_32x32x16_bf16 v[144:159], a[140:143], a[196:199], v[144:159]
    s_waitcnt vmcnt(10) lgkmcnt(0)
    s_barrier
    v_mfma_f32_32x32x16_bf16 v[160:175], a[200:203], a[140:143], v[160:175]
    ds_read_b128 a[144:147], v14 offset:0
    ds_read_b128 a[160:163], v18 offset:0
    ds_read_b128 a[164:167], v20 offset:5120
    v_mfma_f32_32x32x16_bf16 v[176:191], a[204:207], a[140:143], v[176:191]
    ds_read_b128 a[168:171], v22 offset:0
    ds_read_b64_tr_b16 a[172:173], v26 offset:0
    ds_read_b64_tr_b16 a[174:175], v26 offset:512
    v_mfma_f32_32x32x16_bf16 v[192:207], a[208:211], a[140:143], v[192:207]
    ds_read_b64_tr_b16 a[176:177], v27 offset:0
    ds_read_b64_tr_b16 a[178:179], v27 offset:512
    ds_read_b64_tr_b16 a[180:181], v26 offset:8192
    v_mfma_f32_32x32x16_bf16 v[208:223], a[212:215], a[140:143], v[208:223]
    ds_read_b64_tr_b16 a[182:183], v26 offset:8704
    ds_read_b64_tr_b16 a[184:185], v27 offset:8192
    ds_read_b64_tr_b16 a[186:187], v27 offset:8704
    s_waitcnt lgkmcnt(9)
    v_mfma_f32_32x32x16_bf16 v[112:127], a[144:147], a[160:163], v[112:127]
    s_add_u32 m0, s49, 32768
    s_mul_i32 s45, s65, 196608
    buffer_load_dwordx4 v12, s[20:23], s45 offen lds
    v_mfma_f32_32x32x16_bf16 v[128:143], a[144:147], a[164:167], v[128:143]
    ds_read_b128 a[148:151], v15 offset:0
    ds_read_b128 a[188:191], v19 offset:0
    ds_read_b128 a[192:195], v21 offset:5120
    s_waitcnt lgkmcnt(9)
    v_mfma_f32_32x32x16_bf16 v[144:159], a[144:147], a[168:171], v[144:159]
    s_add_u32 m0, s49, 36864
    s_nop 0
    buffer_load_dwordx4 v12, s[24:27], s45 offen lds
    s_add_u32 s65, s65, 1
    s_cmp_eq_u32 s65, 10
    s_cselect_b32 s65, 2, s65
    v_mfma_f32_32x32x16_bf16 v[160:175], a[172:175], a[144:147], v[160:175]
    ds_read_b128 a[196:199], v23 offset:0
    ds_read_b64_tr_b16 a[200:201], v26 offset:2048
    ds_read_b64_tr_b16 a[202:203], v26 offset:2560
    s_waitcnt lgkmcnt(8)
    v_mfma_f32_32x32x16_bf16 v[176:191], a[176:179], a[144:147], v[176:191]
    s_add_u32 m0, s49, 40960
    s_mul_i32 s45, s65, 196608
    buffer_load_dwordx4 v12, s[20:23], s45 offen lds
    v_mfma_f32_32x32x16_bf16 v[192:207], a[180:183], a[144:147], v[192:207]
    ds_read_b64_tr_b16 a[204:205], v27 offset:2048
    ds_read_b64_tr_b16 a[206:207], v27 offset:2560
    ds_read_b64_tr_b16 a[208:209], v26 offset:10240
    s_waitcnt lgkmcnt(9)
    v_mfma_f32_32x32x16_bf16 v[208:223], a[184:187], a[144:147], v[208:223]
    ds_read_b64_tr_b16 a[210:211], v26 offset:10752
    ds_read_b64_tr_b16 a[212:213], v27 offset:10240
    ds_read_b64_tr_b16 a[214:215], v27 offset:10752
    s_waitcnt lgkmcnt(9)
    v_mfma_f32_32x32x16_bf16 v[112:127], a[148:151], a[188:191], v[112:127]
    s_add_u32 m0, s49, 45056
    s_nop 0
    buffer_load_dwordx4 v12, s[24:27], s45 offen lds
    s_add_u32 s65, s65, 1
    s_cmp_eq_u32 s65, 10
    s_cselect_b32 s65, 2, s65
    v_mfma_f32_32x32x16_bf16 v[128:143], a[148:151], a[192:195], v[128:143]
    ds_read_b128 a[152:155], v16 offset:0
    ds_read_b128 a[160:163], v20 offset:0
    ds_read_b128 a[164:167], v18 offset:5120
    s_waitcnt lgkmcnt(9)
    v_mfma_f32_32x32x16_bf16 v[144:159], a[148:151], a[196:199], v[144:159]
    s_add_u32 m0, s49, 69888
    s_mul_i32 s45, s65, 196608
    buffer_load_dwordx4 v12, s[20:23], s45 offen lds
    v_mfma_f32_32x32x16_bf16 v[160:175], a[200:203], a[148:151], v[160:175]
    ds_read_b128 a[168:171], v24 offset:0
    ds_read_b64_tr_b16 a[172:173], v26 offset:4096
    ds_read_b64_tr_b16 a[174:175], v26 offset:4608
    s_waitcnt lgkmcnt(8)
    v_mfma_f32_32x32x16_bf16 v[176:191], a[204:207], a[148:151], v[176:191]
    s_add_u32 m0, s49, 73984
    s_nop 0
    buffer_load_dwordx4 v12, s[24:27], s45 offen lds
    s_add_u32 s65, s65, 1
    s_cmp_eq_u32 s65, 10
    s_cselect_b32 s65, 2, s65
    v_mfma_f32_32x32x16_bf16 v[192:207], a[208:211], a[148:151], v[192:207]
    ds_read_b64_tr_b16 a[176:177], v27 offset:4096
    ds_read_b64_tr_b16 a[178:179], v27 offset:4608
    ds_read_b64_tr_b16 a[180:181], v26 offset:12288
    s_waitcnt lgkmcnt(9)
    v_mfma_f32_32x32x16_bf16 v[208:223], a[212:215], a[148:151], v[208:223]
    ds_read_b64_tr_b16 a[182:183], v26 offset:12800
    ds_read_b64_tr_b16 a[184:185], v27 offset:12288
    ds_read_b64_tr_b16 a[186:187], v27 offset:12800
    s_waitcnt lgkmcnt(9)
    v_mfma_f32_32x32x16_bf16 v[112:127], a[152:155], a[160:163], v[112:127]
    v_mfma_f32_32x32x16_bf16 v[128:143], a[152:155], a[164:167], v[128:143]
    ds_read_b128 a[156:159], v17 offset:0
    ds_read_b128 a[188:191], v21 offset:0
    ds_read_b128 a[192:195], v19 offset:5120
    s_waitcnt lgkmcnt(9)
    v_mfma_f32_32x32x16_bf16 v[144:159], a[152:155], a[168:171], v[144:159]
    v_mfma_f32_32x32x16_bf16 v[160:175], a[172:175], a[152:155], v[160:175]
    ds_read_b128 a[196:199], v25 offset:0
    ds_read_b64_tr_b16 a[200:201], v26 offset:6144
    ds_read_b64_tr_b16 a[202:203], v26 offset:6656
    s_waitcnt lgkmcnt(8)
    v_mfma_f32_32x32x16_bf16 v[176:191], a[176:179], a[152:155], v[176:191]
    v_mfma_f32_32x32x16_bf16 v[192:207], a[180:183], a[152:155], v[192:207]
    ds_read_b64_tr_b16 a[204:205], v27 offset:6144
    ds_read_b64_tr_b16 a[206:207], v27 offset:6656
    ds_read_b64_tr_b16 a[208:209], v26 offset:14336
    s_waitcnt lgkmcnt(9)
    v_mfma_f32_32x32x16_bf16 v[208:223], a[184:187], a[152:155], v[208:223]
    ds_read_b64_tr_b16 a[210:211], v26 offset:14848
    ds_read_b64_tr_b16 a[212:213], v27 offset:14336
    ds_read_b64_tr_b16 a[214:215], v27 offset:14848
    s_waitcnt lgkmcnt(9)
    v_mfma_f32_32x32x16_bf16 v[112:127], a[156:159], a[188:191], v[112:127]
    v_mfma_f32_32x32x16_bf16 v[128:143], a[156:159], a[192:195], v[128:143]
    s_waitcnt lgkmcnt(6)
    v_mfma_f32_32x32x16_bf16 v[144:159], a[156:159], a[196:199], v[144:159]
    s_waitcnt vmcnt(6) lgkmcnt(0)
    s_barrier
    v_mfma_f32_32x32x16_bf16 v[160:175], a[200:203], a[156:159], v[160:175]
    v_mfma_f32_32x32x16_bf16 v[176:191], a[204:207], a[156:159], v[176:191]
    v_mfma_f32_32x32x16_bf16 v[192:207], a[208:211], a[156:159], v[192:207]
    v_mfma_f32_32x32x16_bf16 v[208:223], a[212:215], a[156:159], v[208:223]
    s_nop 7
    ds_read_b64_tr_b16 a[160:161], v0 offset:40832
    ds_read_b64_tr_b16 a[162:163], v0 offset:41088
    ds_read_b64_tr_b16 a[164:165], v0 offset:44928
    ds_read_b64_tr_b16 a[166:167], v0 offset:45184
    ds_read_b64_tr_b16 a[168:169], v0 offset:41856
    ds_read_b64_tr_b16 a[170:171], v0 offset:42112
    ds_read_b64_tr_b16 a[172:173], v0 offset:45952
    ds_read_b64_tr_b16 a[174:175], v0 offset:46208
    ds_read_b64_tr_b16 a[176:177], v0 offset:42880
    ds_read_b64_tr_b16 a[178:179], v0 offset:43136
    ds_read_b64_tr_b16 a[180:181], v0 offset:46976
    ds_read_b64_tr_b16 a[182:183], v0 offset:47232
    s_waitcnt lgkmcnt(8)
    v_mfma_f32_32x32x16_bf16 v[224:239], a[160:163], a[0:3], 0
    ds_read_b64_tr_b16 a[184:185], v0 offset:43904
    ds_read_b64_tr_b16 a[186:187], v0 offset:44160
    v_lshlrev_b32_e64 v2, 4, v1
    s_mov_b32 s96, 15474688
    buffer_load_dwordx4 v[108:111], v2, s[28:31], s96 offen sc1
    v_mfma_f32_32x32x16_bf16 v[240:255], a[164:167], a[0:3], 0
    ds_read_b64_tr_b16 a[188:189], v0 offset:48000
    ds_read_b64_tr_b16 a[190:191], v0 offset:48256
    v_mov_b32_e64 v3, v2
    v_add_u32 v4, 49152, v2
    v_add_u32 v5, 100352, v2
    v_and_b32 v8, 15, v1
    v_lshlrev_b32 v8, 2, v8
    v_lshlrev_b32 v64, 4, v1
    s_getpc_b64 s[52:53]
TB_11:
    s_add_u32 s52, s52, LANETAB+6144-TB_11
    s_addc_u32 s53, s53, 0
    global_load_dwordx4 v[68:71], v64, s[52:53] offset:0
    s_waitcnt lgkmcnt(8)
    v_mfma_f32_32x32x16_bf16 v[224:239], a[168:171], a[4:7], v[224:239]
    ds_read_b64_tr_b16 a[160:161], v0 offset:49024
    ds_read_b64_tr_b16 a[162:163], v0 offset:49280
    v_bfe_u32 v56, v1, 4, 1
    v_mul_u32_u24 v56, 90112, v56
    v_lshrrev_b32_e64 v57, 5, v1
    v_lshl_add_u32 v56, v57, 8, v56
    v_and_b32_e64 v57, 15, v1
    v_lshl_add_u32 v31, v57, 4, v56
    v_mfma_f32_32x32x16_bf16 v[240:255], a[172:175], a[4:7], v[240:255]
    s_add_u32 m0, s49, 0
    s_mul_i32 s45, s65, 196608
    buffer_load_dwordx4 v12, s[20:23], s45 offen lds
    ds_read_b64_tr_b16 a[164:165], v0 offset:53120
    ds_read_b64_tr_b16 a[166:167], v0 offset:53376
    s_waitcnt lgkmcnt(8)
    v_mfma_f32_32x32x16_bf16 v[224:239], a[176:179], a[8:11], v[224:239]
    ds_read_b64_tr_b16 a[168:169], v0 offset:50048
    ds_read_b64_tr_b16 a[170:171], v0 offset:50304
    v_mul_f32 v58, v160, v192
    v_mul_f32 v59, v161, v193
    v_cvt_pk_bf16_f32 v72, v58, v59
    v_mul_f32 v58, v162, v194
    v_mul_f32 v59, v163, v195
    v_cvt_pk_bf16_f32 v73, v58, v59
    v_mfma_f32_32x32x16_bf16 v[240:255], a[180:183], a[8:11], v[240:255]
    ds_read_b64_tr_b16 a[172:173], v0 offset:54144
    ds_read_b64_tr_b16 a[174:175], v0 offset:54400
    v_mul_f32 v58, v164, v196
    v_mul_f32 v59, v165, v197
    v_cvt_pk_bf16_f32 v74, v58, v59
    v_mul_f32 v58, v166, v198
    v_mul_f32 v59, v167, v199
    v_cvt_pk_bf16_f32 v75, v58, v59
    s_waitcnt lgkmcnt(8)
    v_mfma_f32_32x32x16_bf16 v[224:239], a[184:187], a[12:15], v[224:239]
    ds_read_b64_tr_b16 a[176:177], v0 offset:51072
    ds_read_b64_tr_b16 a[178:179], v0 offset:51328
    v_mul_f32 v58, v168, v200
    v_mul_f32_e64 v59, v169, v201
    v_cvt_pk_bf16_f32 v76, v58, v59
    v_mul_f32 v58, v170, v202
    v_mul_f32 v59, v171, v203
    v_cvt_pk_bf16_f32 v77, v58, v59
    v_mfma_f32_32x32x16_bf16 v[240:255], a[188:191], a[12:15], v[240:255]
    s_add_u32 m0, s49, 4096
    s_nop 0
    buffer_load_dwordx4 v12, s[24:27], s45 offen lds
    s_add_u32 s65, s65, 1
    s_cmp_eq_u32 s65, 10
    s_cselect_b32 s65, 2, s65
    ds_read_b64_tr_b16 a[180:181], v0 offset:55168
    ds_read_b64_tr_b16 a[182:183], v0 offset:55424
    s_waitcnt lgkmcnt(8)
    v_mfma_f32_32x32x16_bf16 v[224:239], a[160:163], a[16:19], v[224:239]
    ds_read_b64_tr_b16 a[184:185], v0 offset:52096
    ds_read_b64_tr_b16 a[186:187], v0 offset:52352
    v_mul_f32 v58, v172, v204
    v_mul_f32_e64 v59, v173, v205
    v_cvt_pk_bf16_f32 v78, v58, v59
    v_mul_f32 v58, v174, v206
    v_mul_f32 v59, v175, v207
    v_cvt_pk_bf16_f32 v79, v58, v59
    v_mfma_f32_32x32x16_bf16 v[240:255], a[164:167], a[16:19], v[240:255]
    ds_read_b64_tr_b16 a[188:189], v0 offset:56192
    ds_read_b64_tr_b16 a[190:191], v0 offset:56448
    buffer_store_dwordx4 v[72:75], v31, s[28:31], s66 offen sc1
    s_waitcnt lgkmcnt(8)
    v_mfma_f32_32x32x16_bf16 v[224:239], a[168:171], a[20:23], v[224:239]
    ds_read_b64_tr_b16 a[160:161], v28 offset:16384
    ds_read_b64_tr_b16 a[162:163], v28 offset:16640
    v_mfma_f32_32x32x16_bf16 v[240:255], a[172:175], a[20:23], v[240:255]
    s_add_u32 m0, s49, 8192
    s_mul_i32 s45, s65, 196608
    buffer_load_dwordx4 v12, s[20:23], s45 offen lds
    ds_read_b64_tr_b16 a[164:165], v28 offset:20480
    ds_read_b64_tr_b16 a[166:167], v28 offset:20736
    s_waitcnt lgkmcnt(8)
    v_mfma_f32_32x32x16_bf16 v[224:239], a[176:179], a[24:27], v[224:239]
    ds_read_b64_tr_b16 a[168:169], v28 offset:17408
    ds_read_b64_tr_b16 a[170:171], v28 offset:17664
    buffer_store_dwordx4 v[76:79], v31, s[28:31], s66 offen offset:512 sc1
    s_nop 1
    v_mfma_f32_32x32x16_bf16 v[240:255], a[180:183], a[24:27], v[240:255]
    ds_read_b64_tr_b16 a[172:173], v28 offset:21504
    ds_read_b64_tr_b16 a[174:175], v28 offset:21760
    v_mul_f32 v58, v176, v208
    v_mul_f32_e64 v59, v177, v209
    v_cvt_pk_bf16_f32 v72, v58, v59
    v_mul_f32 v58, v178, v210
    v_mul_f32 v59, v179, v211
    v_cvt_pk_bf16_f32 v73, v58, v59
    s_waitcnt lgkmcnt(8)
    v_mfma_f32_32x32x16_bf16 v[224:239], a[184:187], a[28:31], v[224:239]
    ds_read_b64_tr_b16 a[176:177], v28 offset:18432
    ds_read_b64_tr_b16 a[178:179], v28 offset:18688
    v_mul_f32 v58, v180, v212
    v_mul_f32_e64 v59, v181, v213
    v_cvt_pk_bf16_f32 v74, v58, v59
    v_mul_f32 v58, v182, v214
    v_mul_f32 v59, v183, v215
    v_cvt_pk_bf16_f32 v75, v58, v59
    v_mfma_f32_32x32x16_bf16 v[240:255], a[188:191], a[28:31], v[240:255]
    s_add_u32 m0, s49, 12288
    s_nop 0
    buffer_load_dwordx4 v12, s[24:27], s45 offen lds
    s_add_u32 s65, s65, 1
    s_cmp_eq_u32 s65, 10
    s_cselect_b32 s65, 2, s65
    ds_read_b64_tr_b16 a[180:181], v28 offset:22528
    ds_read_b64_tr_b16 a[182:183], v28 offset:22784
    s_waitcnt lgkmcnt(8)
    v_mfma_f32_32x32x16_bf16 v[224:239], a[160:163], a[32:35], v[224:239]
    ds_read_b64_tr_b16 a[184:185], v28 offset:19456
    ds_read_b64_tr_b16 a[186:187], v28 offset:19712
    v_mul_f32 v58, v184, v216
    v_mul_f32_e64 v59, v185, v217
    v_cvt_pk_bf16_f32 v76, v58, v59
    v_mul_f32 v58, v186, v218
    v_mul_f32 v59, v187, v219
    v_cvt_pk_bf16_f32 v77, v58, v59
    v_mfma_f32_32x32x16_bf16 v[240:255], a[164:167], a[32:35], v[240:255]
    ds_read_b64_tr_b16 a[188:189], v28 offset:23552
    ds_read_b64_tr_b16 a[190:191], v28 offset:23808
    v_mul_f32 v58, v188, v220
    v_mul_f32 v59, v189, v221
    v_cvt_pk_bf16_f32 v78, v58, v59
    v_mul_f32 v58, v190, v222
    v_mul_f32 v59, v191, v223
    v_cvt_pk_bf16_f32 v79, v58, v59
    s_waitcnt lgkmcnt(8)
    v_mfma_f32_32x32x16_bf16 v[224:239], a[168:171], a[36:39], v[224:239]
    ds_read_b64_tr_b16 a[160:161], v28 offset:24576
    ds_read_b64_tr_b16 a[162:163], v28 offset:24832
    buffer_store_dwordx4 v[72:75], v31, s[28:31], s67 offen sc1
    v_mfma_f32_32x32x16_bf16 v[240:255], a[172:175], a[36:39], v[240:255]
    ds_read_b64_tr_b16 a[164:165], v28 offset:28672
    ds_read_b64_tr_b16 a[166:167], v28 offset:28928
    s_waitcnt lgkmcnt(8)
    v_mfma_f32_32x32x16_bf16 v[224:239], a[176:179], a[40:43], v[224:239]
    ds_read_b64_tr_b16 a[168:169], v28 offset:25600
    ds_read_b64_tr_b16 a[170:171], v28 offset:25856
    buffer_store_dwordx4 v[76:79], v31, s[28:31], s67 offen offset:512 sc1
    s_nop 1
    v_mfma_f32_32x32x16_bf16 v[240:255], a[180:183], a[40:43], v[240:255]
    ds_read_b64_tr_b16 a[172:173], v28 offset:29696
    ds_read_b64_tr_b16 a[174:175], v28 offset:29952
    v_mov_b32 v56, v112
    v_mov_b32_e64 v57, v128
    v_bfe_u32 v63, v1, 3, 1
    v_cmp_eq_u32 s[56:57], 1, v63
    v_sub_f32 v60, 0, v41
    v_mov_b32 v61, v144
    v_cndmask_b32 v60, v60, v41, s[56:57]
    s_waitcnt lgkmcnt(8)
    v_mfma_f32_32x32x16_bf16 v[224:239], a[184:187], a[44:47], v[224:239]
    ds_read_b64_tr_b16 a[176:177], v28 offset:26624
    ds_read_b64_tr_b16 a[178:179], v28 offset:26880
    v_fma_f32 v62, v40, v61, v145
    v_fma_f32 v58, v32, v56, v113
    v_fma_f32 v59, v32, v57, v129
    v_fma_f32 v58, -v33, v57, v58
    v_fmac_f32 v59, v33, v56
    v_fmac_f32_dpp v62, v61, v60 row_ror:8 row_mask:0xf bank_mask:0xf
    v_mfma_f32_32x32x16_bf16 v[240:255], a[188:191], a[44:47], v[240:255]
    ds_read_b64_tr_b16 a[180:181], v28 offset:30720
    ds_read_b64_tr_b16 a[182:183], v28 offset:30976
    v_fma_f32 v61, v40, v62, v146
    v_fma_f32 v56, v32, v58, v114
    v_fma_f32 v57, v32, v59, v130
    v_fma_f32 v56, -v33, v59, v56
    v_fmac_f32_e64 v57, v33, v58
    v_fmac_f32_dpp v61, v62, v60 row_ror:8 row_mask:0xf bank_mask:0xf
    s_waitcnt lgkmcnt(8)
    v_mfma_f32_32x32x16_bf16 v[224:239], a[160:163], a[48:51], v[224:239]
    ds_read_b64_tr_b16 a[184:185], v28 offset:27648
    ds_read_b64_tr_b16 a[186:187], v28 offset:27904
    v_fma_f32 v62, v40, v61, v147
    v_fma_f32 v58, v32, v56, v115
    v_fma_f32 v59, v32, v57, v131
    v_fma_f32 v58, -v33, v57, v58
    v_fmac_f32 v59, v33, v56
    v_fmac_f32_dpp v62, v61, v60 row_ror:8 row_mask:0xf bank_mask:0xf
    v_mfma_f32_32x32x16_bf16 v[240:255], a[164:167], a[48:51], v[240:255]
    ds_read_b64_tr_b16 a[188:189], v28 offset:31744
    ds_read_b64_tr_b16 a[190:191], v28 offset:32000
    v_fma_f32 v61, v40, v62, v148
    v_fma_f32 v56, v32, v58, v116
    v_fma_f32 v57, v32, v59, v132
    v_fma_f32 v56, -v33, v59, v56
    v_fmac_f32_e64 v57, v33, v58
    v_fmac_f32_dpp v61, v62, v60 row_ror:8 row_mask:0xf bank_mask:0xf
    s_waitcnt lgkmcnt(8)
    v_mfma_f32_32x32x16_bf16 v[224:239], a[168:171], a[52:55], v[224:239]
    ds_read_b64_tr_b16 a[160:161], v29 offset:10368
    ds_read_b64_tr_b16 a[162:163], v29 offset:10624
    v_fma_f32 v62, v40, v61, v149
    v_fma_f32 v58, v32, v56, v117
    v_fma_f32 v59, v32, v57, v133
    v_fma_f32 v58, -v33, v57, v58
    v_fmac_f32 v59, v33, v56
    v_fmac_f32_dpp v62, v61, v60 row_ror:8 row_mask:0xf bank_mask:0xf
    v_mfma_f32_32x32x16_bf16 v[240:255], a[172:175], a[52:55], v[240:255]
    ds_read_b64_tr_b16 a[164:165], v29 offset:14464
    ds_read_b64_tr_b16 a[166:167], v29 offset:14720
    v_fma_f32 v61, v40, v62, v150
    v_fma_f32 v56, v32, v58, v118
    v_fma_f32 v57, v32, v59, v134
    v_fma_f32 v56, -v33, v59, v56
    v_fmac_f32_e64 v57, v33, v58
    v_fmac_f32_dpp v61, v62, v60 row_ror:8 row_mask:0xf bank_mask:0xf
    s_waitcnt lgkmcnt(8)
    v_mfma_f32_32x32x16_bf16 v[224:239], a[176:179], a[56:59], v[224:239]
    ds_read_b64_tr_b16 a[168:169], v29 offset:11392
    ds_read_b64_tr_b16 a[170:171], v29 offset:11648
    v_fma_f32 v62, v40, v61, v151
    v_fma_f32 v58, v32, v56, v119
    v_fma_f32 v59, v32, v57, v135
    v_fma_f32 v58, -v33, v57, v58
    v_fmac_f32 v59, v33, v56
    v_fmac_f32_dpp v62, v61, v60 row_ror:8 row_mask:0xf bank_mask:0xf
    v_mfma_f32_32x32x16_bf16 v[240:255], a[180:183], a[56:59], v[240:255]
    ds_read_b64_tr_b16 a[172:173], v29 offset:15488
    ds_read_b64_tr_b16 a[174:175], v29 offset:15744
    v_fma_f32 v61, v40, v62, v152
    v_fma_f32 v56, v32, v58, v120
    v_fma_f32 v57, v32, v59, v136
    v_fma_f32 v56, -v33, v59, v56
    v_fmac_f32_e64 v57, v33, v58
    v_fmac_f32_dpp v61, v62, v60 row_ror:8 row_mask:0xf bank_mask:0xf
    s_waitcnt lgkmcnt(8)
    v_mfma_f32_32x32x16_bf16 v[224:239], a[184:187], a[60:63], v[224:239]
    ds_read_b64_tr_b16 a[176:177], v29 offset:12416
    ds_read_b64_tr_b16 a[178:179], v29 offset:12672
    v_fma_f32 v62, v40, v61, v153
    v_fma_f32 v58, v32, v56, v121
    v_fma_f32 v59, v32, v57, v137
    v_fma_f32 v58, -v33, v57, v58
    v_fmac_f32 v59, v33, v56
    v_fmac_f32_dpp v62, v61, v60 row_ror:8 row_mask:0xf bank_mask:0xf
    v_mfma_f32_32x32x16_bf16 v[240:255], a[188:191], a[60:63], v[240:255]
    ds_read_b64_tr_b16 a[180:181], v29 offset:16512
    ds_read_b64_tr_b16 a[182:183], v29 offset:16768
    v_fma_f32 v61, v40, v62, v154
    v_fma_f32 v56, v32, v58, v122
    v_fma_f32 v57, v32, v59, v138
    v_fma_f32 v56, -v33, v59, v56
    v_fmac_f32_e64 v57, v33, v58
    v_fmac_f32_dpp v61, v62, v60 row_ror:8 row_mask:0xf bank_mask:0xf
    s_waitcnt lgkmcnt(8)
    v_mfma_f32_32x32x16_bf16 v[224:239], a[160:163], a[64:67], v[224:239]
    ds_read_b64_tr_b16 a[184:185], v29 offset:13440
    ds_read_b64_tr_b16 a[186:187], v29 offset:13696
    v_fma_f32 v62, v40, v61, v155
    v_fma_f32 v58, v32, v56, v123
    v_fma_f32 v59, v32, v57, v139
    v_fma_f32 v58, -v33, v57, v58
    v_fmac_f32 v59, v33, v56
    v_fmac_f32_dpp v62, v61, v60 row_ror:8 row_mask:0xf bank_mask:0xf
    v_mfma_f32_32x32x16_bf16 v[240:255], a[164:167], a[64:67], v[240:255]
    ds_read_b64_tr_b16 a[188:189], v29 offset:17536
    ds_read_b64_tr_b16 a[190:191], v29 offset:17792
    v_fma_f32 v61, v40, v62, v156
    v_fma_f32 v56, v32, v58, v124
    v_fma_f32 v57, v32, v59, v140
    v_fma_f32 v56, -v33, v59, v56
    v_fmac_f32_e64 v57, v33, v58
    v_fmac_f32_dpp v61, v62, v60 row_ror:8 row_mask:0xf bank_mask:0xf
    s_waitcnt lgkmcnt(8)
    v_mfma_f32_32x32x16_bf16 v[224:239], a[168:171], a[68:71], v[224:239]
    s_waitcnt vmcnt(9)
    s_cmp_lg_u32 s4, 0
    s_cbranch_scc1 SPD_13
    s_mov_b32 s60, 40000
SP_12:
    v_cmp_ne_u32 s[100:101], s50, v108
    v_cmp_ne_u32 vcc, s50, v109
    s_or_b64 s[100:101], s[100:101], vcc
    v_cmp_ne_u32 vcc, s50, v110
    s_or_b64 s[100:101], s[100:101], vcc
    v_cmp_ne_u32 vcc, s50, v111
    s_or_b64 s[100:101], s[100:101], vcc
    s_nop 0
    s_cmp_eq_u64 s[100:101], 0
    s_cbranch_scc1 SPD_13
    s_sub_u32 s60, s60, 1
    s_cmp_eq_u32 s60, 0
    s_cbranch_scc1 SPD_13
    s_sleep 4
    buffer_load_dwordx4 v[108:111], v2, s[28:31], s96 offen sc1
    s_waitcnt vmcnt(0)
    s_branch SP_12
SPD_13:
    s_waitcnt lgkmcnt(0)
    s_barrier
    v_fma_f32 v62, v40, v61, v157
    v_fma_f32 v58, v32, v56, v125
    v_fma_f32 v59, v32, v57, v141
    v_fma_f32 v58, -v33, v57, v58
    v_fmac_f32 v59, v33, v56
    v_fmac_f32_dpp v62, v61, v60 row_ror:8 row_mask:0xf bank_mask:0xf
    v_fma_f32 v61, v40, v62, v158
    v_fma_f32 v56, v32, v58, v126
    v_fma_f32 v57, v32, v59, v142
    v_fma_f32 v56, -v33, v59, v56
    v_fmac_f32_e64 v57, v33, v58
    v_fmac_f32_dpp v61, v62, v60 row_ror:8 row_mask:0xf bank_mask:0xf
    v_fma_f32 v62, v40, v61, v159
    v_fma_f32 v58, v32, v56, v127
    v_fma_f32 v59, v32, v57, v143
    v_fma_f32 v58, -v33, v57, v58
    v_fmac_f32_e64 v59, v33, v56
    v_fmac_f32_dpp v62, v61, v60 row_ror:8 row_mask:0xf bank_mask:0xf
    s_waitcnt vmcnt(8)
    s_lshl_b32 s52, s4, 10
    s_add_u32 s52, s52, 132992
    v_add_u32 v66, s52, v68
    v_add_u32 v67, s52, v69
    v_add_u32_e64 v68, s52, v70
    ds_write_b64 v66, v[58:59]
    v_and_b32 v65, 31, v1
    v_cmp_gt_u32 vcc, 16, v65
    s_and_saveexec_b64 s[52:53], vcc
    ds_write_b32 v68, v62
    s_mov_b64 exec, s[52:53]
    v_subrev_u32 v69, 3584, v66
    v_subrev_u32 v70, 3584, v67
    s_waitcnt lgkmcnt(0)
    s_barrier
    ds_read_b64_tr_b16 a[160:161], v28 offset:32768
    ds_read_b64_tr_b16 a[162:163], v28 offset:33024
    s_add_u32 m0, s98, 80256
    s_add_u32 s42, s51, 0
    buffer_load_dwordx4 v2, s[28:31], s42 offen sc1 lds
    v_mfma_f32_32x32x16_bf16 v[240:255], a[172:175], a[68:71], v[240:255]
    ds_read_b64_tr_b16 a[164:165], v28 offset:36864
    ds_read_b64_tr_b16 a[166:167], v28 offset:37120
    buffer_load_dwordx4 v2, s[28:31], s42 offen offset:1024 sc1 lds
    ds_read_b64 v[72:73], v66
    ds_read_b64 v[74:75], v69 offset:3072
    v_mfma_f32_32x32x16_bf16 v[224:239], a[176:179], a[72:75], v[224:239]
    ds_read_b64_tr_b16 a[168:169], v28 offset:33792
    ds_read_b64_tr_b16 a[170:171], v28 offset:34048
    buffer_load_dwordx4 v2, s[28:31], s42 offen offset:2048 sc1 lds
    ds_read_b64 v[76:77], v69 offset:2560
    ds_read_b64 v[78:79], v69 offset:2048
    v_mfma_f32_32x32x16_bf16 v[240:255], a[180:183], a[72:75], v[240:255]
    ds_read_b64_tr_b16 a[172:173], v28 offset:37888
    ds_read_b64_tr_b16 a[174:175], v28 offset:38144
    buffer_load_dwordx4 v2, s[28:31], s42 offen offset:3072 sc1 lds
    ds_read_b64 v[80:81], v69 offset:1536
    ds_read_b64 v[82:83], v69 offset:1024
    v_mfma_f32_32x32x16_bf16 v[224:239], a[184:187], a[76:79], v[224:239]
    ds_read_b64_tr_b16 a[176:177], v28 offset:34816
    ds_read_b64_tr_b16 a[178:179], v28 offset:35072
    s_add_u32 m0, s98, 84352
    s_add_u32 s42, s42, 4096
    buffer_load_dwordx4 v2, s[28:31], s42 offen sc1 lds
    v_mfma_f32_32x32x16_bf16 v[240:255], a[188:191], a[76:79], v[240:255]
    ds_read_b64_tr_b16 a[180:181], v28 offset:38912
    ds_read_b64_tr_b16 a[182:183], v28 offset:39168
    s_add_u32 m0, s98, 100736
    s_add_u32 s42, s51, 20480
    buffer_load_dwordx4 v2, s[28:31], s42 offen sc1 lds
    s_waitcnt lgkmcnt(14)
    v_mfma_f32_32x32x16_bf16 v[224:239], a[160:163], a[80:83], v[224:239]
    ds_read_b64_tr_b16 a[184:185], v28 offset:35840
    ds_read_b64_tr_b16 a[186:187], v28 offset:36096
    buffer_load_dwordx4 v2, s[28:31], s42 offen offset:1024 sc1 lds
    ds_read_b64 v[84:85], v69 offset:512
    ds_read_b64 v[86:87], v69 offset:0
    v_mfma_f32_32x32x16_bf16 v[240:255], a[164:167], a[80:83], v[240:255]
    ds_read_b64_tr_b16 a[188:189], v28 offset:39936
    ds_read_b64_tr_b16 a[190:191], v28 offset:40192
    buffer_load_dwordx4 v2, s[28:31], s42 offen offset:2048 sc1 lds
    ds_read_b64 v[88:89], v67
    ds_read_b64 v[90:91], v70 offset:3072
    s_waitcnt lgkmcnt(14)
    v_mfma_f32_32x32x16_bf16 v[224:239], a[168:171], a[84:87], v[224:239]
    s_waitcnt vmcnt(8)
    s_barrier
    s_mov_b64 exec, 1
    buffer_store_dword a255, off, s[28:31], s70 sc0 sc1
    s_mov_b64 exec, -1
    ds_read_b64_tr_b16 a[160:161], v28 offset:40960
    ds_read_b64_tr_b16 a[162:163], v28 offset:41216
    buffer_load_dwordx4 v2, s[28:31], s42 offen offset:3072 sc1 lds
    v_mfma_f32_32x32x16_bf16 v[240:255], a[172:175], a[84:87], v[240:255]
    ds_read_b64_tr_b16 a[164:165], v28 offset:45056
    ds_read_b64_tr_b16 a[166:167], v28 offset:45312
    s_add_u32 m0, s98, 104832
    s_add_u32 s42, s42, 4096
    buffer_load_dwordx4 v2, s[28:31], s42 offen sc1 lds
    s_waitcnt lgkmcnt(12)
    v_mfma_f32_32x32x16_bf16 v[224:239], a[176:179], a[88:91], v[224:239]
    ds_read_b64_tr_b16 a[168:169], v28 offset:41984
    ds_read_b64_tr_b16 a[170:171], v28 offset:42240
    s_add_u32 m0, s98, 49152
    s_add_u32 s42, s51, 40960
    buffer_load_dwordx4 v2, s[28:31], s42 offen sc1 lds
    v_mfma_f32_32x32x16_bf16 v[240:255], a[180:183], a[88:91], v[240:255]
    ds_read_b64_tr_b16 a[172:173], v28 offset:46080
    ds_read_b64_tr_b16 a[174:175], v28 offset:46336
    buffer_load_dwordx4 v2, s[28:31], s42 offen offset:1024 sc1 lds
    ds_read_b64 v[92:93], v70 offset:2560
    ds_read_b64 v[94:95], v70 offset:2048
    s_waitcnt lgkmcnt(12)
    v_mfma_f32_32x32x16_bf16 v[224:239], a[184:187], a[92:95], v[224:239]
    ds_read_b64_tr_b16 a[176:177], v28 offset:43008
    ds_read_b64_tr_b16 a[178:179], v28 offset:43264
    buffer_load_dwordx4 v2, s[28:31], s42 offen offset:2048 sc1 lds
    ds_read_b64 v[96:97], v70 offset:1536
    ds_read_b64 v[98:99], v70 offset:1024
    v_mfma_f32_32x32x16_bf16 v[240:255], a[188:191], a[92:95], v[240:255]
    ds_read_b64_tr_b16 a[180:181], v28 offset:47104
    ds_read_b64_tr_b16 a[182:183], v28 offset:47360
    buffer_load_dwordx4 v2, s[28:31], s42 offen offset:3072 sc1 lds
    ds_read_b64 v[100:101], v70 offset:512
    ds_read_b64 v[102:103], v70 offset:0
    s_waitcnt lgkmcnt(14)
    v_mfma_f32_32x32x16_bf16 v[224:239], a[160:163], a[96:99], v[224:239]
    ds_read_b64_tr_b16 a[184:185], v28 offset:44032
    ds_read_b64_tr_b16 a[186:187], v28 offset:44288
    s_add_u32 m0, s98, 53248
    s_add_u32 s42, s42, 4096
    buffer_load_dwordx4 v2, s[28:31], s42 offen sc1 lds
    v_mfma_f32_32x32x16_bf16 v[240:255], a[164:167], a[96:99], v[240:255]
    ds_read_b64_tr_b16 a[188:189], v28 offset:48128
    ds_read_b64_tr_b16 a[190:191], v28 offset:48384
    s_waitcnt lgkmcnt(14)
    v_mfma_f32_32x32x16_bf16 v[224:239], a[168:171], a[100:103], v[224:239]
    ds_read_b64_tr_b16 a[160:161], v29 offset:20736
    ds_read_b64_tr_b16 a[162:163], v29 offset:20992
    v_mfma_f32_32x32x16_bf16 v[240:255], a[172:175], a[100:103], v[240:255]
    ds_read_b64_tr_b16 a[164:165], v29 offset:24832
    ds_read_b64_tr_b16 a[166:167], v29 offset:25088
    s_waitcnt lgkmcnt(10)
    v_mfma_f32_32x32x16_bf16 v[224:239], a[176:179], a[104:107], v[224:239]
    ds_read_b64_tr_b16 a[168:169], v29 offset:21760
    ds_read_b64_tr_b16 a[170:171], v29 offset:22016
    v_fma_f32 v104, v34, v86, v84
    v_fma_f32 v105, v34, v87, v85
    v_fma_f32 v104, -v35, v87, v104
    v_fmac_f32_e64 v105, v35, v86
    v_fma_f32 v106, v34, v104, v82
    v_fma_f32 v107, v34, v105, v83
    v_mfma_f32_32x32x16_bf16 v[240:255], a[180:183], a[104:107], v[240:255]
    ds_read_b64_tr_b16 a[172:173], v29 offset:25856
    ds_read_b64_tr_b16 a[174:175], v29 offset:26112
    v_fma_f32 v106, -v35, v105, v106
    v_fmac_f32_e64 v107, v35, v104
    v_fma_f32 v104, v34, v106, v80
    v_fma_f32 v105, v34, v107, v81
    v_fma_f32 v104, -v35, v107, v104
    v_fmac_f32 v105, v35, v106
    s_waitcnt lgkmcnt(8)
    v_mfma_f32_32x32x16_bf16 v[224:239], a[184:187], a[108:111], v[224:239]
    ds_read_b64_tr_b16 a[176:177], v29 offset:22784
    ds_read_b64_tr_b16 a[178:179], v29 offset:23040
    v_fma_f32 v106, v34, v104, v78
    v_fma_f32 v107, v34, v105, v79
    v_fma_f32 v106, -v35, v105, v106
    v_fmac_f32_e64 v107, v35, v104
    v_fma_f32 v104, v34, v106, v76
    v_fma_f32 v105, v34, v107, v77
    v_mfma_f32_32x32x16_bf16 v[240:255], a[188:191], a[108:111], v[240:255]
    ds_read_b64_tr_b16 a[180:181], v29 offset:26880
    ds_read_b64_tr_b16 a[182:183], v29 offset:27136
    v_fma_f32 v104, -v35, v107, v104
    v_fmac_f32_e64 v105, v35, v106
    v_fma_f32 v52, v34, v104, v74
    v_fma_f32 v53, v34, v105, v75
    v_fma_f32 v52, -v35, v105, v52
    v_fmac_f32 v53, v35, v104
    s_waitcnt lgkmcnt(8)
    v_mfma_f32_32x32x16_bf16 v[224:239], a[160:163], a[112:115], v[224:239]
    ds_read_b64_tr_b16 a[184:185], v29 offset:23808
    ds_read_b64_tr_b16 a[186:187], v29 offset:24064
    v_fma_f32 v104, v42, v102, v100
    v_fma_f32 v105, v42, v103, v101
    v_fma_f32 v104, -v43, v103, v104
    v_fmac_f32_e64 v105, v43, v102
    v_fma_f32 v106, v42, v104, v98
    v_fma_f32 v107, v42, v105, v99
    v_mfma_f32_32x32x16_bf16 v[240:255], a[164:167], a[112:115], v[240:255]
    ds_read_b64_tr_b16 a[188:189], v29 offset:27904
    ds_read_b64_tr_b16 a[190:191], v29 offset:28160
    v_fma_f32 v106, -v43, v105, v106
    v_fmac_f32_e64 v107, v43, v104
    v_fma_f32 v104, v42, v106, v96
    v_fma_f32 v105, v42, v107, v97
    v_fma_f32 v104, -v43, v107, v104
    v_fmac_f32 v105, v43, v106
    s_waitcnt lgkmcnt(8)
    v_mfma_f32_32x32x16_bf16 v[224:239], a[168:171], a[116:119], v[224:239]
    ds_read_b64_tr_b16 a[160:161], v28 offset:0
    ds_read_b64_tr_b16 a[162:163], v28 offset:256
    v_fma_f32 v106, v42, v104, v94
    v_fma_f32 v107, v42, v105, v95
    v_fma_f32 v106, -v43, v105, v106
    v_fmac_f32_e64 v107, v43, v104
    v_fma_f32 v104, v42, v106, v92
    v_fma_f32 v105, v42, v107, v93
    v_mfma_f32_32x32x16_bf16 v[240:255], a[172:175], a[116:119], v[240:255]
    ds_read_b64_tr_b16 a[164:165], v28 offset:4096
    ds_read_b64_tr_b16 a[166:167], v28 offset:4352
    v_fma_f32 v104, -v43, v107, v104
    v_fmac_f32_e64 v105, v43, v106
    v_fma_f32 v54, v42, v104, v90
    v_fma_f32 v55, v42, v105, v91
    v_fma_f32 v54, -v43, v105, v54
    v_fmac_f32 v55, v43, v104
    s_waitcnt lgkmcnt(8)
    v_mfma_f32_32x32x16_bf16 v[224:239], a[176:179], a[120:123], v[224:239]
    ds_read_b64_tr_b16 a[168:169], v28 offset:1024
    ds_read_b64_tr_b16 a[170:171], v28 offset:1280
    v_fma_f32 v104, v34, v52, v72
    v_fma_f32 v106, v34, v53, v73
    v_fma_f32 v104, -v35, v53, v104
    v_fmac_f32_e64 v106, v35, v52
    v_fma_f32 v76, v42, v54, v88
    v_fma_f32 v78, v42, v55, v89
    v_fma_f32 v76, -v43, v55, v76
    v_fmac_f32_e64 v78, v43, v54
    v_mfma_f32_32x32x16_bf16 v[240:255], a[180:183], a[120:123], v[240:255]
    ds_read_b64_tr_b16 a[172:173], v28 offset:5120
    ds_read_b64_tr_b16 a[174:175], v28 offset:5376
    v_mov_b32 v105, s50
    v_mov_b32 v107, s50
    v_mov_b32 v77, s50
    v_mov_b32 v79, s50
    v_lshlrev_b32 v68, 4, v65
    s_mov_b32 exec_lo, 0
    buffer_store_dwordx4 v[104:107], v68, s[28:31], s69 offen sc0 sc1
    s_mov_b32 exec_hi, 0xff
    buffer_store_dwordx4 v[76:79], v68, s[28:31], s69 offen offset:512 sc0 sc1
    s_mov_b64 exec, -1
    s_waitcnt lgkmcnt(8)
    v_mfma_f32_32x32x16_bf16 v[224:239], a[184:187], a[124:127], v[224:239]
    ds_read_b64_tr_b16 a[176:177], v28 offset:2048
    ds_read_b64_tr_b16 a[178:179], v28 offset:2304
    v_lshlrev_b32 v57, 4, v1
    s_getpc_b64 s[52:53]
TB_14:
    s_add_u32 s52, s52, LANETAB+5120-TB_14
    s_addc_u32 s53, s53, 0
    global_load_dwordx4 v[100:103], v57, s[52:53] offset:0
    v_mfma_f32_32x32x16_bf16 v[240:255], a[188:191], a[124:127], v[240:255]
    ds_read_b64_tr_b16 a[180:181], v28 offset:6144
    ds_read_b64_tr_b16 a[182:183], v28 offset:6400
    s_mov_b32 s32, s90
    s_and_b32 s33, s91, 0xffff
    s_mov_b32 s34, 1280
    s_mov_b32 s35, 0x20000
    v_lshrrev_b32 v184, 5, v1
    v_and_b32 v185, 31, v1
    s_waitcnt lgkmcnt(8)
    v_mfma_f32_32x32x16_bf16 v[224:239], a[160:163], a[128:131], v[224:239]
    ds_read_b64_tr_b16 a[184:185], v28 offset:3072
    ds_read_b64_tr_b16 a[186:187], v28 offset:3328
    s_lshl_b32 s52, s5, 7
    s_lshl_b32 s53, s6, 3
    s_add_u32 s52, s52, s53
    s_lshl_b32 s53, s4, 1
    s_add_u32 s52, s52, s53
    s_movk_i32 s55, 1280
    v_mfma_f32_32x32x16_bf16 v[240:255], a[164:167], a[128:131], v[240:255]
    ds_read_b64_tr_b16 a[188:189], v28 offset:7168
    ds_read_b64_tr_b16 a[190:191], v28 offset:7424
    v_add_u32 v196, s52, v184
    v_mul_lo_u32 v186, v196, s55
    v_lshl_add_u32 v186, v185, 4, v186
    v_lshlrev_b32 v187, 4, v185
    v_cmp_gt_u32 vcc, 16, v185
    v_mov_b32 v188, 0x7fff0000
    s_nop 0
    v_cndmask_b32 v188, v188, v186, vcc
    s_waitcnt lgkmcnt(8)
    v_mfma_f32_32x32x16_bf16 v[224:239], a[168:171], a[132:135], v[224:239]
    ds_read_b64_tr_b16 a[160:161], v28 offset:8192
    ds_read_b64_tr_b16 a[162:163], v28 offset:8448
    buffer_load_dwordx4 v[160:163], v186, s[8:11], 0 offen offset:0
    v_mfma_f32_32x32x16_bf16 v[240:255], a[172:175], a[132:135], v[240:255]
    ds_read_b64_tr_b16 a[164:165], v28 offset:12288
    ds_read_b64_tr_b16 a[166:167], v28 offset:12544
    s_waitcnt lgkmcnt(8)
    v_mfma_f32_32x32x16_bf16 v[224:239], a[176:179], a[136:139], v[224:239]
    ds_read_b64_tr_b16 a[168:169], v28 offset:9216
    ds_read_b64_tr_b16 a[170:171], v28 offset:9472
    buffer_load_dwordx4 v[172:175], v187, s[32:35], 0 offen offset:0
    v_mfma_f32_32x32x16_bf16 v[240:255], a[180:183], a[136:139], v[240:255]
    ds_read_b64_tr_b16 a[172:173], v28 offset:13312
    ds_read_b64_tr_b16 a[174:175], v28 offset:13568
    s_waitcnt lgkmcnt(8)
    v_mfma_f32_32x32x16_bf16 v[224:239], a[184:187], a[140:143], v[224:239]
    ds_read_b64_tr_b16 a[176:177], v28 offset:10240
    ds_read_b64_tr_b16 a[178:179], v28 offset:10496
    buffer_load_dwordx4 v[164:167], v186, s[8:11], 0 offen offset:512
    v_mfma_f32_32x32x16_bf16 v[240:255], a[188:191], a[140:143], v[240:255]
    ds_read_b64_tr_b16 a[180:181], v28 offset:14336
    ds_read_b64_tr_b16 a[182:183], v28 offset:14592
    s_waitcnt lgkmcnt(8)
    v_mfma_f32_32x32x16_bf16 v[224:239], a[160:163], a[144:147], v[224:239]
    ds_read_b64_tr_b16 a[184:185], v28 offset:11264
    ds_read_b64_tr_b16 a[186:187], v28 offset:11520
    buffer_load_dwordx4 v[176:179], v187, s[32:35], 0 offen offset:512
    v_mfma_f32_32x32x16_bf16 v[240:255], a[164:167], a[144:147], v[240:255]
    ds_read_b64_tr_b16 a[188:189], v28 offset:15360
    ds_read_b64_tr_b16 a[190:191], v28 offset:15616
    s_waitcnt lgkmcnt(8)
    v_mfma_f32_32x32x16_bf16 v[224:239], a[168:171], a[148:151], v[224:239]
    buffer_load_dwordx4 v[168:171], v188, s[8:11], 0 offen offset:1024
    v_mfma_f32_32x32x16_bf16 v[240:255], a[172:175], a[148:151], v[240:255]
    s_waitcnt lgkmcnt(4)
    v_mfma_f32_32x32x16_bf16 v[224:239], a[176:179], a[152:155], v[224:239]
    buffer_load_dwordx4 v[180:183], v187, s[32:35], 0 offen offset:1024
    v_mfma_f32_32x32x16_bf16 v[240:255], a[180:183], a[152:155], v[240:255]
    s_waitcnt lgkmcnt(0)
    v_mfma_f32_32x32x16_bf16 v[224:239], a[184:187], a[156:159], v[224:239]
    v_mfma_f32_32x32x16_bf16 v[240:255], a[188:191], a[156:159], v[240:255]
    s_nop 7
    s_nop 3
    v_mul_f32 v58, v224, v240
    v_mul_f32_e64 v59, v225, v241
    v_cvt_pk_bf16_f32 v72, v58, v59
    v_mul_f32 v58, v226, v242
    v_mul_f32 v59, v227, v243
    v_cvt_pk_bf16_f32 v73, v58, v59
    v_mul_f32 v58, v228, v244
    v_mul_f32 v59, v229, v245
    v_cvt_pk_bf16_f32 v74, v58, v59
    v_mul_f32 v58, v230, v246
    v_mul_f32 v59, v231, v247
    v_cvt_pk_bf16_f32 v75, v58, v59
    v_mul_f32 v58, v232, v248
    v_mul_f32 v59, v233, v249
    v_cvt_pk_bf16_f32 v76, v58, v59
    v_mul_f32 v58, v234, v250
    v_mul_f32 v59, v235, v251
    v_cvt_pk_bf16_f32 v77, v58, v59
    v_mul_f32 v58, v236, v252
    v_mul_f32 v59, v237, v253
    v_cvt_pk_bf16_f32 v78, v58, v59
    v_mul_f32 v58, v238, v254
    v_mul_f32 v59, v239, v255
    v_cvt_pk_bf16_f32 v79, v58, v59
    buffer_store_dwordx4 v[72:75], v31, s[28:31], s68 offen sc1
    buffer_store_dwordx4 v[76:79], v31, s[28:31], s68 offen offset:512 sc1
    s_nop 1
    v_and_b32 v56, 7, v1
    v_add_u32 v56, 32, v56
    v_cmp_gt_u32 vcc, 32, v1
    s_nop 1
    v_cndmask_b32 v56, v56, v1, vcc
    v_lshlrev_b32_e64 v56, 4, v56
    v_bfe_u32 v57, v1, 3, 1
    v_cmp_eq_u32 s[56:57], 1, v57
    v_sub_f32 v60, 0, v46
    v_sub_f32 v61, 0, v47
    v_cndmask_b32 v60, v46, v60, s[56:57]
    v_pk_mul_f32 v[80:81], v[112:113], v[38:39] op_sel_hi:[1,0]
    v_pk_mul_f32 v[82:83], v[128:129], v[38:39] op_sel_hi:[1,0] neg_lo:[0,1] neg_hi:[0,1]
    v_mul_f32 v232, v60, v144
    v_mul_f32 v233, v60, v145
    v_pk_fma_f32 v[80:81], v[128:129], v[38:39], v[80:81] op_sel:[0,1,0] op_sel_hi:[1,1,1] neg_lo:[0,1,0] neg_hi:[0,1,0]
    v_pk_fma_f32 v[128:129], v[112:113], v[38:39], v[82:83] op_sel:[0,1,0] op_sel_hi:[1,1,1] neg_lo:[0,1,0] neg_hi:[0,1,0]
    v_fmac_f32_dpp v232, v144, v61 row_ror:8 row_mask:0xf bank_mask:0xf
    v_fmac_f32_dpp v233, v145, v61 row_ror:8 row_mask:0xf bank_mask:0xf
    v_pk_mul_f32 v[112:113], v[80:81], 1.0 op_sel_hi:[1,0]
    v_pk_mul_f32 v[80:81], v[114:115], v[38:39] op_sel_hi:[1,0]
    v_pk_mul_f32 v[82:83], v[130:131], v[38:39] op_sel_hi:[1,0] neg_lo:[0,1] neg_hi:[0,1]
    v_mul_f32 v234, v60, v146
    v_mul_f32 v235, v60, v147
    v_pk_fma_f32 v[80:81], v[130:131], v[38:39], v[80:81] op_sel:[0,1,0] op_sel_hi:[1,1,1] neg_lo:[0,1,0] neg_hi:[0,1,0]
    v_pk_fma_f32 v[130:131], v[114:115], v[38:39], v[82:83] op_sel:[0,1,0] op_sel_hi:[1,1,1] neg_lo:[0,1,0] neg_hi:[0,1,0]
    v_fmac_f32_dpp v234, v146, v61 row_ror:8 row_mask:0xf bank_mask:0xf
    v_fmac_f32_dpp v235, v147, v61 row_ror:8 row_mask:0xf bank_mask:0xf
    v_pk_mul_f32 v[114:115], v[80:81], 1.0 op_sel_hi:[1,0]
    v_pk_mul_f32 v[80:81], v[116:117], v[38:39] op_sel_hi:[1,0]
    v_pk_mul_f32 v[82:83], v[132:133], v[38:39] op_sel_hi:[1,0] neg_lo:[0,1] neg_hi:[0,1]
    v_mul_f32 v236, v60, v148
    v_mul_f32 v237, v60, v149
    v_pk_fma_f32 v[80:81], v[132:133], v[38:39], v[80:81] op_sel:[0,1,0] op_sel_hi:[1,1,1] neg_lo:[0,1,0] neg_hi:[0,1,0]
    v_pk_fma_f32 v[132:133], v[116:117], v[38:39], v[82:83] op_sel:[0,1,0] op_sel_hi:[1,1,1] neg_lo:[0,1,0] neg_hi:[0,1,0]
    v_fmac_f32_dpp v236, v148, v61 row_ror:8 row_mask:0xf bank_mask:0xf
    v_fmac_f32_dpp v237, v149, v61 row_ror:8 row_mask:0xf bank_mask:0xf
    v_pk_mul_f32 v[116:117], v[80:81], 1.0 op_sel_hi:[1,0]
    v_pk_mul_f32 v[80:81], v[118:119], v[38:39] op_sel_hi:[1,0]
    v_pk_mul_f32 v[82:83], v[134:135], v[38:39] op_sel_hi:[1,0] neg_lo:[0,1] neg_hi:[0,1]
    v_mul_f32 v238, v60, v150
    v_mul_f32 v239, v60, v151
    v_pk_fma_f32 v[80:81], v[134:135], v[38:39], v[80:81] op_sel:[0,1,0] op_sel_hi:[1,1,1] neg_lo:[0,1,0] neg_hi:[0,1,0]
    v_pk_fma_f32 v[134:135], v[118:119], v[38:39], v[82:83] op_sel:[0,1,0] op_sel_hi:[1,1,1] neg_lo:[0,1,0] neg_hi:[0,1,0]
    v_fmac_f32_dpp v238, v150, v61 row_ror:8 row_mask:0xf bank_mask:0xf
    v_fmac_f32_dpp v239, v151, v61 row_ror:8 row_mask:0xf bank_mask:0xf
    v_pk_mul_f32 v[118:119], v[80:81], 1.0 op_sel_hi:[1,0]
    v_pk_mul_f32 v[80:81], v[120:121], v[38:39] op_sel_hi:[1,0]
    v_pk_mul_f32 v[82:83], v[136:137], v[38:39] op_sel_hi:[1,0] neg_lo:[0,1] neg_hi:[0,1]
    v_mul_f32 v240, v60, v152
    v_mul_f32 v241, v60, v153
    v_pk_fma_f32 v[80:81], v[136:137], v[38:39], v[80:81] op_sel:[0,1,0] op_sel_hi:[1,1,1] neg_lo:[0,1,0] neg_hi:[0,1,0]
    v_pk_fma_f32 v[136:137], v[120:121], v[38:39], v[82:83] op_sel:[0,1,0] op_sel_hi:[1,1,1] neg_lo:[0,1,0] neg_hi:[0,1,0]
    v_fmac_f32_dpp v240, v152, v61 row_ror:8 row_mask:0xf bank_mask:0xf
    v_fmac_f32_dpp v241, v153, v61 row_ror:8 row_mask:0xf bank_mask:0xf
    v_pk_mul_f32 v[120:121], v[80:81], 1.0 op_sel_hi:[1,0]
    v_pk_mul_f32 v[80:81], v[122:123], v[38:39] op_sel_hi:[1,0]
    v_pk_mul_f32 v[82:83], v[138:139], v[38:39] op_sel_hi:[1,0] neg_lo:[0,1] neg_hi:[0,1]
    v_mul_f32 v242, v60, v154
    v_mul_f32 v243, v60, v155
    v_pk_fma_f32 v[80:81], v[138:139], v[38:39], v[80:81] op_sel:[0,1,0] op_sel_hi:[1,1,1] neg_lo:[0,1,0] neg_hi:[0,1,0]
    v_pk_fma_f32 v[138:139], v[122:123], v[38:39], v[82:83] op_sel:[0,1,0] op_sel_hi:[1,1,1] neg_lo:[0,1,0] neg_hi:[0,1,0]
    v_fmac_f32_dpp v242, v154, v61 row_ror:8 row_mask:0xf bank_mask:0xf
    v_fmac_f32_dpp v243, v155, v61 row_ror:8 row_mask:0xf bank_mask:0xf
    v_pk_mul_f32 v[122:123], v[80:81], 1.0 op_sel_hi:[1,0]
    v_pk_mul_f32 v[80:81], v[124:125], v[38:39] op_sel_hi:[1,0]
    v_pk_mul_f32 v[82:83], v[140:141], v[38:39] op_sel_hi:[1,0] neg_lo:[0,1] neg_hi:[0,1]
    v_mul_f32 v244, v60, v156
    v_mul_f32 v245, v60, v157
    v_pk_fma_f32 v[80:81], v[140:141], v[38:39], v[80:81] op_sel:[0,1,0] op_sel_hi:[1,1,1] neg_lo:[0,1,0] neg_hi:[0,1,0]
    v_pk_fma_f32 v[140:141], v[124:125], v[38:39], v[82:83] op_sel:[0,1,0] op_sel_hi:[1,1,1] neg_lo:[0,1,0] neg_hi:[0,1,0]
    v_fmac_f32_dpp v244, v156, v61 row_ror:8 row_mask:0xf bank_mask:0xf
    v_fmac_f32_dpp v245, v157, v61 row_ror:8 row_mask:0xf bank_mask:0xf
    v_pk_mul_f32 v[124:125], v[80:81], 1.0 op_sel_hi:[1,0]
    v_pk_mul_f32 v[80:81], v[126:127], v[38:39] op_sel_hi:[1,0]
    v_pk_mul_f32 v[82:83], v[142:143], v[38:39] op_sel_hi:[1,0] neg_lo:[0,1] neg_hi:[0,1]
    v_mul_f32 v246, v60, v158
    v_mul_f32 v247, v60, v159
    v_pk_fma_f32 v[80:81], v[142:143], v[38:39], v[80:81] op_sel:[0,1,0] op_sel_hi:[1,1,1] neg_lo:[0,1,0] neg_hi:[0,1,0]
    v_pk_fma_f32 v[142:143], v[126:127], v[38:39], v[82:83] op_sel:[0,1,0] op_sel_hi:[1,1,1] neg_lo:[0,1,0] neg_hi:[0,1,0]
    v_fmac_f32_dpp v246, v158, v61 row_ror:8 row_mask:0xf bank_mask:0xf
    v_fmac_f32_dpp v247, v159, v61 row_ror:8 row_mask:0xf bank_mask:0xf
    v_pk_mul_f32 v[126:127], v[80:81], 1.0 op_sel_hi:[1,0]
    v_mul_f32 v80, v38, v52
    v_mul_f32 v81, v38, v53
    v_fma_f32 v80, -v39, v53, v80
    v_fmac_f32 v81, v39, v52
    v_mov_b32 v52, v80
    v_sub_f32 v53, 0, v81
    v_mul_f32 v80, v46, v54
    v_mul_f32_e64 v81, v46, v55
    v_fma_f32 v80, -v47, v55, v80
    v_fmac_f32 v81, v47, v54
    v_mov_b32 v54, v80
    v_sub_f32 v55, 0, v81
    v_mul_f32 v80, v36, v38
    v_mul_f32_e64 v81, v36, v39
    v_fma_f32 v80, -v37, v39, v80
    v_fmac_f32 v81, v37, v38
    v_mov_b32 v36, v80
    v_mov_b32 v37, v81
    v_mul_f32 v80, v44, v46
    v_mul_f32_e64 v81, v44, v47
    v_fma_f32 v80, -v45, v47, v80
    v_fmac_f32 v81, v45, v46
    v_mov_b32 v44, v80
    v_mov_b32_e64 v45, v81
    buffer_load_dword v108, v8, s[28:31], s79 offen offset:0 sc1
    buffer_load_dwordx4 v[64:67], v56, s[28:31], s84 offen sc0 sc1
    buffer_load_dwordx4 v[68:71], v56, s[28:31], s85 offen sc0 sc1
    buffer_load_dwordx4 v[72:75], v56, s[28:31], s86 offen sc0 sc1
    buffer_load_dwordx4 v[76:79], v56, s[28:31], s87 offen sc0 sc1
    s_waitcnt vmcnt(13)
    s_mul_i32 s52, s4, 5760
    s_add_u32 s52, s52, 139136
    v_add_u32 v100, s52, v100
    v_add_u32 v101, s52, v101
    v_add_u32 v102, s52, v102
    v_sub_f32 v104, 0, v41
    v_sub_f32 v105, 0, v33
    s_nop 0
    v_cndmask_b32 v104, v41, v104, s[56:57]
    s_mov_b32 s52, 0x3f803f80
    v_mov_b32 v186, 0
    s_waitcnt vmcnt(7)
    v_and_b32 v184, 0xffff, v172
    v_and_b32 v185, 0xffff0000, v172
    v_dot2_f32_bf16 v188, v160, v184, 0
    v_dot2_f32_bf16 v189, v160, v185, 0
    v_and_b32 v184, 0xffff, v173
    v_and_b32 v185, 0xffff0000, v173
    v_dot2_f32_bf16 v190, v161, v184, 0
    v_dot2_f32_bf16 v191, v161, v185, 0
    v_and_b32 v184, 0xffff, v174
    v_and_b32 v185, 0xffff0000, v174
    v_dot2_f32_bf16 v192, v162, v184, 0
    v_dot2_f32_bf16 v193, v162, v185, 0
    v_cvt_pk_bf16_f32 v194, v188, v189
    v_dot2_f32_bf16 v186, v194, s52, v186
    v_and_b32 v184, 0xffff, v175
    v_and_b32 v185, 0xffff0000, v175
    v_dot2_f32_bf16 v188, v163, v184, 0
    v_dot2_f32_bf16 v189, v163, v185, 0
    v_cvt_pk_bf16_f32 v194, v190, v191
    v_dot2_f32_bf16 v186, v194, s52, v186
    v_and_b32 v184, 0xffff, v176
    v_and_b32 v185, 0xffff0000, v176
    v_dot2_f32_bf16 v190, v164, v184, 0
    v_dot2_f32_bf16 v191, v164, v185, 0
    v_cvt_pk_bf16_f32 v194, v192, v193
    v_dot2_f32_bf16 v186, v194, s52, v186
    v_and_b32 v184, 0xffff, v177
    v_and_b32 v185, 0xffff0000, v177
    v_dot2_f32_bf16 v192, v165, v184, 0
    v_dot2_f32_bf16 v193, v165, v185, 0
    v_cvt_pk_bf16_f32 v194, v188, v189
    v_dot2_f32_bf16 v186, v194, s52, v186
    v_and_b32 v184, 0xffff, v178
    v_and_b32 v185, 0xffff0000, v178
    v_dot2_f32_bf16 v188, v166, v184, 0
    v_dot2_f32_bf16 v189, v166, v185, 0
    v_cvt_pk_bf16_f32 v194, v190, v191
    v_dot2_f32_bf16 v186, v194, s52, v186
    v_and_b32 v184, 0xffff, v179
    v_and_b32 v185, 0xffff0000, v179
    v_dot2_f32_bf16 v190, v167, v184, 0
    v_dot2_f32_bf16 v191, v167, v185, 0
    v_cvt_pk_bf16_f32 v194, v192, v193
    v_dot2_f32_bf16 v186, v194, s52, v186
    v_and_b32 v184, 0xffff, v180
    v_and_b32 v185, 0xffff0000, v180
    v_dot2_f32_bf16 v192, v168, v184, 0
    v_dot2_f32_bf16 v193, v168, v185, 0
    v_cvt_pk_bf16_f32 v194, v188, v189
    v_dot2_f32_bf16 v186, v194, s52, v186
    v_and_b32 v184, 0xffff, v181
    v_and_b32 v185, 0xffff0000, v181
    v_dot2_f32_bf16 v188, v169, v184, 0
    v_dot2_f32_bf16 v189, v169, v185, 0
    v_cvt_pk_bf16_f32 v194, v190, v191
    v_dot2_f32_bf16 v186, v194, s52, v186
    v_and_b32 v184, 0xffff, v182
    v_and_b32 v185, 0xffff0000, v182
    v_dot2_f32_bf16 v190, v170, v184, 0
    v_dot2_f32_bf16 v191, v170, v185, 0
    v_cvt_pk_bf16_f32 v194, v192, v193
    v_dot2_f32_bf16 v186, v194, s52, v186
    v_and_b32 v184, 0xffff, v183
    v_and_b32 v185, 0xffff0000, v183
    v_dot2_f32_bf16 v192, v171, v184, 0
    v_dot2_f32_bf16 v193, v171, v185, 0
    v_cvt_pk_bf16_f32 v194, v188, v189
    v_dot2_f32_bf16 v186, v194, s52, v186
    s_nop 1
    v_cvt_pk_bf16_f32 v194, v190, v191
    v_dot2_f32_bf16 v186, v194, s52, v186
    s_nop 1
    v_cvt_pk_bf16_f32 v194, v192, v193
    v_dot2_f32_bf16 v186, v194, s52, v186
    s_nop 2
    s_nop 1
    v_add_f32_dpp v186, v186, v186 row_ror:1 row_mask:0xf bank_mask:0xf
    s_nop 1
    v_add_f32_dpp v186, v186, v186 row_ror:2 row_mask:0xf bank_mask:0xf
    s_nop 1
    v_add_f32_dpp v186, v186, v186 row_ror:4 row_mask:0xf bank_mask:0xf
    s_nop 1
    v_add_f32_dpp v186, v186, v186 row_ror:8 row_mask:0xf bank_mask:0xf
    v_mov_b32 v187, v186
    s_nop 1
    v_permlane16_swap_b32 v186, v187
    v_add_f32 v186, v186, v187
    v_cvt_pk_bf16_f32 v186, v186, v186
    v_lshlrev_b32_e64 v186, 16, v186
    v_mul_f32 v186, 0xbfb8aa3b, v186
    v_exp_f32 v186, v186
    s_nop 0
    v_add_f32 v186, 1.0, v186
    v_rcp_f32 v186, v186
    s_nop 0
    v_cvt_pk_bf16_f32 v186, v186, v186
    v_lshlrev_b32 v186, 16, v186
    v_lshlrev_b32_e64 v187, 2, v196
    v_add_u32 v187, 15138816, v187
    v_and_b32 v188, 31, v1
    v_cmp_eq_u32 vcc, 0, v188
    s_and_saveexec_b64 s[52:53], vcc
    buffer_store_dword v186, v187, s[28:31], 0 offen sc1
    s_mov_b64 exec, s[52:53]
    s_waitcnt vmcnt(5)
    s_cmp_lg_u32 s4, 0
    s_cbranch_scc1 SPD_16
    s_mov_b32 s60, 40000
SP_15:
    v_cmp_ne_u32 s[100:101], s50, v108
    s_nop 0
    s_cmp_eq_u64 s[100:101], 0
    s_cbranch_scc1 SPD_16
    s_sub_u32 s60, s60, 1
    s_cmp_eq_u32 s60, 0
    s_cbranch_scc1 SPD_16
    s_sleep 1
    buffer_load_dword v108, v8, s[28:31], s79 offen offset:0 sc1
    s_waitcnt vmcnt(0)
    s_branch SP_15
SPD_16:
    s_waitcnt lgkmcnt(0)
    s_barrier
    s_add_u32 s45, s44, 0
    buffer_load_dwordx4 a[0:3], v2, s[28:31], s45 offen sc1
    buffer_load_dwordx4 a[4:7], v2, s[28:31], s45 offen offset:1024 sc1
    buffer_load_dwordx4 a[8:11], v2, s[28:31], s45 offen offset:2048 sc1
    buffer_load_dwordx4 a[12:15], v2, s[28:31], s45 offen offset:3072 sc1
    s_add_u32 s45, s44, 4096
    buffer_load_dwordx4 a[16:19], v2, s[28:31], s45 offen sc1
    buffer_load_dwordx4 a[20:23], v2, s[28:31], s45 offen offset:1024 sc1
    buffer_load_dwordx4 a[24:27], v2, s[28:31], s45 offen offset:2048 sc1
    buffer_load_dwordx4 a[28:31], v2, s[28:31], s45 offen offset:3072 sc1
    s_waitcnt vmcnt(9)
    s_mov_b32 s61, 40000
LB_17:
    s_mov_b64 s[52:53], 0
    v_cmp_ne_u32 vcc, s88, v65
    s_or_b64 s[52:53], s[52:53], vcc
    v_cmp_ne_u32 vcc, s88, v67
    s_or_b64 s[52:53], s[52:53], vcc
    v_cmp_ne_u32 vcc, s89, v69
    s_or_b64 s[52:53], s[52:53], vcc
    v_cmp_ne_u32 vcc, s89, v71
    s_or_b64 s[52:53], s[52:53], vcc
    v_cmp_ne_u32 vcc, s94, v73
    s_or_b64 s[52:53], s[52:53], vcc
    v_cmp_ne_u32 vcc, s94, v75
    s_or_b64 s[52:53], s[52:53], vcc
    v_cmp_ne_u32 vcc, s95, v77
    s_or_b64 s[52:53], s[52:53], vcc
    v_cmp_ne_u32 vcc, s95, v79
    s_or_b64 s[52:53], s[52:53], vcc
    s_cmp_eq_u64 s[52:53], 0
    s_cbranch_scc1 LBD_18
    s_sub_u32 s61, s61, 1
    s_cmp_eq_u32 s61, 0
    s_cbranch_scc1 LBD_18
    s_sleep 1
    buffer_load_dwordx4 v[64:67], v56, s[28:31], s84 offen sc0 sc1
    buffer_load_dwordx4 v[68:71], v56, s[28:31], s85 offen sc0 sc1
    buffer_load_dwordx4 v[72:75], v56, s[28:31], s86 offen sc0 sc1
    buffer_load_dwordx4 v[76:79], v56, s[28:31], s87 offen sc0 sc1
    s_waitcnt vmcnt(0)
    s_branch LB_17
LBD_18:
    v_fma_f32 v80, v48, v76, v72
    v_fma_f32 v81, v48, v78, v74
    v_fma_f32 v80, -v49, v78, v80
    v_fmac_f32 v81, v49, v76
    v_fma_f32 v82, v48, v80, v68
    v_fma_f32 v83, v48, v81, v70
    v_fma_f32 v82, -v49, v81, v82
    v_fmac_f32_e64 v83, v49, v80
    v_fma_f32 v80, v48, v82, v64
    v_fma_f32 v81, v48, v83, v66
    v_fma_f32 v80, -v49, v83, v80
    v_fmac_f32 v81, v49, v82
    v_lshlrev_b32 v57, 3, v1
    s_lshl_b32 s52, s4, 9
    s_add_u32 s52, s52, 137088
    v_add_u32 v58, s52, v57
    ds_write_b64 v58, v[80:81]
    v_add_u32 v57, 137088, v57
    s_waitcnt lgkmcnt(0)
    s_barrier
    ds_read_b64 v[84:85], v57 offset:0
    ds_read_b64 v[86:87], v57 offset:512
    ds_read_b64 v[88:89], v57 offset:1024
    ds_read_b64 v[90:91], v57 offset:1536
    s_waitcnt lgkmcnt(0)
    v_fma_f32 v80, v50, v90, v88
    v_fma_f32 v81, v50, v91, v89
    v_fma_f32 v80, -v51, v91, v80
    v_fmac_f32 v81, v51, v90
    v_fma_f32 v82, v50, v80, v86
    v_fma_f32 v83, v50, v81, v87
    s_add_u32 m0, s98, 0
    s_add_u32 s42, s51, 61440
    buffer_load_dwordx4 v2, s[28:31], s42 offen sc1 lds
    v_fma_f32 v82, -v51, v81, v82
    v_fmac_f32 v83, v51, v80
    v_fma_f32 v80, v50, v82, v84
    v_fma_f32 v81, v50, v83, v85
    v_fma_f32 v80, -v51, v83, v80
    v_fmac_f32 v81, v51, v82
    v_mov_b32 v92, v80
    v_mov_b32 v94, v80
    s_nop 1
    v_permlane32_swap_b32 v92, v94
    buffer_load_dwordx4 v2, s[28:31], s42 offen offset:1024 sc1 lds
    v_mov_b32 v93, v81
    v_mov_b32 v95, v81
    s_nop 1
    v_permlane32_swap_b32 v93, v95
    v_fma_f32 v96, v36, v92, v52
    v_fma_f32 v97, -v36, v93, v53
    v_fma_f32 v96, -v37, v93, v96
    v_fma_f32 v97, -v37, v92, v97
    v_fma_f32 v98, v44, v94, v54
    v_fma_f32 v99, -v44, v95, v55
    buffer_load_dwordx4 v2, s[28:31], s42 offen offset:2048 sc1 lds
    v_fma_f32 v98, -v45, v95, v98
    v_fma_f32 v99, -v45, v94, v99
    v_cndmask_b32 v73, v98, v99, s[56:57]
    s_nop 0
    v_fmac_f32 v232, v40, v73
    v_fmac_f32 v112, v32, v96
    v_fmac_f32 v128, v32, v97
    v_fmac_f32 v112, v33, v97
    v_fmac_f32_e64 v128, v105, v96
    v_fmac_f32_dpp v232, v73, v104 row_ror:8 row_mask:0xf bank_mask:0xf
    v_fmac_f32 v233, v40, v232
    v_fmac_f32 v113, v32, v112
    buffer_load_dwordx4 v2, s[28:31], s42 offen offset:3072 sc1 lds
    v_fmac_f32 v129, v32, v128
    v_fmac_f32 v113, v33, v128
    v_fmac_f32_e64 v129, v105, v112
    v_fmac_f32_dpp v233, v232, v104 row_ror:8 row_mask:0xf bank_mask:0xf
    v_cvt_pk_bf16_f32 v76, v112, v113
    v_cvt_pk_bf16_f32 v84, v128, v129
    v_cvt_pk_bf16_f32 v92, v232, v233
    v_fmac_f32 v234, v40, v233
    v_fmac_f32 v114, v32, v113
    v_fmac_f32 v130, v32, v129
    v_fmac_f32 v114, v33, v129
    s_add_u32 m0, s98, 4096
    s_add_u32 s42, s42, 4096
    buffer_load_dwordx4 v2, s[28:31], s42 offen sc1 lds
    v_fmac_f32_e64 v130, v105, v113
    v_fmac_f32_dpp v234, v233, v104 row_ror:8 row_mask:0xf bank_mask:0xf
    v_fmac_f32 v235, v40, v234
    v_fmac_f32 v115, v32, v114
    v_fmac_f32 v131, v32, v130
    v_fmac_f32 v115, v33, v130
    v_fmac_f32_e64 v131, v105, v114
    v_fmac_f32_dpp v235, v234, v104 row_ror:8 row_mask:0xf bank_mask:0xf
    v_cvt_pk_bf16_f32 v77, v114, v115
    v_cvt_pk_bf16_f32 v85, v130, v131
    v_cvt_pk_bf16_f32 v93, v234, v235
    s_add_u32 s45, s44, 8192
    buffer_load_dwordx4 a[32:35], v2, s[28:31], s45 offen sc1
    v_fmac_f32 v236, v40, v235
    v_fmac_f32 v116, v32, v115
    v_fmac_f32 v132, v32, v131
    v_fmac_f32 v116, v33, v131
    v_fmac_f32_e64 v132, v105, v115
    v_fmac_f32_dpp v236, v235, v104 row_ror:8 row_mask:0xf bank_mask:0xf
    v_fmac_f32 v237, v40, v236
    v_fmac_f32 v117, v32, v116
    v_fmac_f32 v133, v32, v132
    v_fmac_f32 v117, v33, v132
    v_fmac_f32_e64 v133, v105, v116
    v_fmac_f32_dpp v237, v236, v104 row_ror:8 row_mask:0xf bank_mask:0xf
    buffer_load_dwordx4 a[36:39], v2, s[28:31], s45 offen offset:1024 sc1
    v_cvt_pk_bf16_f32 v78, v116, v117
    v_cvt_pk_bf16_f32 v86, v132, v133
    v_cvt_pk_bf16_f32 v94, v236, v237
    v_fmac_f32 v238, v40, v237
    v_fmac_f32 v118, v32, v117
    v_fmac_f32 v134, v32, v133
    v_fmac_f32 v118, v33, v133
    v_fmac_f32_e64 v134, v105, v117
    v_fmac_f32_dpp v238, v237, v104 row_ror:8 row_mask:0xf bank_mask:0xf
    v_fmac_f32 v239, v40, v238
    v_fmac_f32 v119, v32, v118
    buffer_load_dwordx4 a[40:43], v2, s[28:31], s45 offen offset:2048 sc1
    v_fmac_f32 v135, v32, v134
    v_fmac_f32 v119, v33, v134
    v_fmac_f32_e64 v135, v105, v118
    v_fmac_f32_dpp v239, v238, v104 row_ror:8 row_mask:0xf bank_mask:0xf
    v_cvt_pk_bf16_f32 v79, v118, v119
    v_cvt_pk_bf16_f32 v87, v134, v135
    v_cvt_pk_bf16_f32 v95, v238, v239
    v_fmac_f32 v240, v40, v239
    v_fmac_f32 v120, v32, v119
    v_fmac_f32 v136, v32, v135
    v_fmac_f32 v120, v33, v135
    buffer_load_dwordx4 a[44:47], v2, s[28:31], s45 offen offset:3072 sc1
    v_fmac_f32_e64 v136, v105, v119
    v_fmac_f32_dpp v240, v239, v104 row_ror:8 row_mask:0xf bank_mask:0xf
    v_fmac_f32 v241, v40, v240
    v_fmac_f32 v121, v32, v120
    v_fmac_f32 v137, v32, v136
    v_fmac_f32 v121, v33, v136
    v_fmac_f32_e64 v137, v105, v120
    v_fmac_f32_dpp v241, v240, v104 row_ror:8 row_mask:0xf bank_mask:0xf
    v_cvt_pk_bf16_f32 v80, v120, v121
    v_cvt_pk_bf16_f32 v88, v136, v137
    v_cvt_pk_bf16_f32 v96, v240, v241
    s_add_u32 s45, s44, 12288
    buffer_load_dwordx4 a[48:51], v2, s[28:31], s45 offen sc1
    v_fmac_f32 v242, v40, v241
    v_fmac_f32 v122, v32, v121
    v_fmac_f32 v138, v32, v137
    v_fmac_f32 v122, v33, v137
    v_fmac_f32_e64 v138, v105, v121
    v_fmac_f32_dpp v242, v241, v104 row_ror:8 row_mask:0xf bank_mask:0xf
    v_fmac_f32 v243, v40, v242
    v_fmac_f32 v123, v32, v122
    v_fmac_f32 v139, v32, v138
    v_fmac_f32 v123, v33, v138
    v_fmac_f32_e64 v139, v105, v122
    v_fmac_f32_dpp v243, v242, v104 row_ror:8 row_mask:0xf bank_mask:0xf
    buffer_load_dwordx4 a[52:55], v2, s[28:31], s45 offen offset:1024 sc1
    v_cvt_pk_bf16_f32 v81, v122, v123
    v_cvt_pk_bf16_f32 v89, v138, v139
    v_cvt_pk_bf16_f32 v97, v242, v243
    v_fmac_f32 v244, v40, v243
    v_fmac_f32 v124, v32, v123
    v_fmac_f32 v140, v32, v139
    v_fmac_f32 v124, v33, v139
    v_fmac_f32_e64 v140, v105, v123
    v_fmac_f32_dpp v244, v243, v104 row_ror:8 row_mask:0xf bank_mask:0xf
    v_fmac_f32 v245, v40, v244
    v_fmac_f32 v125, v32, v124
    buffer_load_dwordx4 a[56:59], v2, s[28:31], s45 offen offset:2048 sc1
    v_fmac_f32 v141, v32, v140
    v_fmac_f32 v125, v33, v140
    v_fmac_f32_e64 v141, v105, v124
    v_fmac_f32_dpp v245, v244, v104 row_ror:8 row_mask:0xf bank_mask:0xf
    v_cvt_pk_bf16_f32 v82, v124, v125
    v_cvt_pk_bf16_f32 v90, v140, v141
    v_cvt_pk_bf16_f32 v98, v244, v245
    v_fmac_f32 v246, v40, v245
    v_fmac_f32 v126, v32, v125
    v_fmac_f32 v142, v32, v141
    v_fmac_f32 v126, v33, v141
    buffer_load_dwordx4 a[60:63], v2, s[28:31], s45 offen offset:3072 sc1
    v_fmac_f32_e64 v142, v105, v125
    v_fmac_f32_dpp v246, v245, v104 row_ror:8 row_mask:0xf bank_mask:0xf
    v_fmac_f32 v247, v40, v246
    v_fmac_f32 v127, v32, v126
    v_fmac_f32 v143, v32, v142
    v_fmac_f32 v127, v33, v142
    v_fmac_f32_e64 v143, v105, v126
    v_fmac_f32_dpp v247, v246, v104 row_ror:8 row_mask:0xf bank_mask:0xf
    v_cvt_pk_bf16_f32 v83, v126, v127
    v_cvt_pk_bf16_f32 v91, v142, v143
    v_cvt_pk_bf16_f32 v99, v246, v247
    s_add_u32 m0, s98, 20480
    s_add_u32 s42, s51, 81920
    buffer_load_dwordx4 v2, s[28:31], s42 offen sc1 lds
    ds_write_b64 v100, v[76:77] offset:0
    ds_write_b64 v100, v[78:79] offset:8
    ds_write_b64 v100, v[80:81] offset:16
    ds_write_b64 v100, v[82:83] offset:24
    ds_write_b64 v100, v[84:85] offset:2304
    ds_write_b64 v100, v[86:87] offset:2312
    ds_write_b64 v100, v[88:89] offset:2320
    ds_write_b64 v100, v[90:91] offset:2328
    v_and_b32 v68, 31, v1
    v_cmp_gt_u32 vcc, 16, v68
    s_and_saveexec_b64 s[54:55], vcc
    ds_write_b64 v100, v[92:93] offset:4608
    ds_write_b64 v100, v[94:95] offset:4616
    ds_write_b64 v100, v[96:97] offset:4624
    ds_write_b64 v100, v[98:99] offset:4632
    s_mov_b64 exec, s[54:55]
    buffer_load_dwordx4 v2, s[28:31], s42 offen offset:1024 sc1 lds
    buffer_load_dwordx4 v2, s[28:31], s42 offen offset:2048 sc1 lds
    buffer_load_dwordx4 v2, s[28:31], s42 offen offset:3072 sc1 lds
    s_add_u32 m0, s98, 24576
    s_add_u32 s42, s42, 4096
    buffer_load_dwordx4 v2, s[28:31], s42 offen sc1 lds
    s_waitcnt vmcnt(22)
    s_barrier
    s_mov_b64 exec, 1
    buffer_store_dword a255, off, s[28:31], s71 sc0 sc1
    s_mov_b64 exec, -1
    ds_read_b128 a[64:67], v4 offset:31104
    ds_read_b128 a[68:71], v4 offset:32128
    ds_read_b128 a[72:75], v4 offset:33152
    ds_read_b128 a[76:79], v4 offset:34176
    ds_read_b128 a[80:83], v4 offset:35200
    s_waitcnt lgkmcnt(3)
    v_mfma_f32_16x16x32_bf16 v[160:163], a[0:3], a[64:67], 0
    ds_read_b128 a[84:87], v4 offset:36224
    v_mfma_f32_16x16x32_bf16 v[164:167], a[0:3], a[68:71], 0
    ds_read_b128 a[88:91], v4 offset:37248
    s_waitcnt lgkmcnt(3)
    v_mfma_f32_16x16x32_bf16 v[168:171], a[0:3], a[72:75], 0
    ds_read_b128 a[92:95], v4 offset:38272
    v_mfma_f32_16x16x32_bf16 v[172:175], a[0:3], a[76:79], 0
    ds_read_b128 a[96:99], v4 offset:39296
    ds_read_b64_tr_b16 v[76:77], v101 offset:0
    ds_read_b64_tr_b16 v[78:79], v101 offset:288
    ds_read_b64_tr_b16 v[80:81], v101 offset:576
    s_waitcnt lgkmcnt(7)
    v_mfma_f32_16x16x32_bf16 v[176:179], a[0:3], a[80:83], 0
    ds_read_b128 a[100:103], v4 offset:40320
    ds_read_b64_tr_b16 v[82:83], v101 offset:864
    ds_read_b64_tr_b16 v[84:85], v101 offset:1152
    ds_read_b64_tr_b16 v[86:87], v101 offset:1440
    s_waitcnt lgkmcnt(9)
    v_mfma_f32_16x16x32_bf16 v[160:163], a[4:7], a[84:87], v[160:163]
    ds_read_b128 a[64:67], v4 offset:41344
    ds_read_b64_tr_b16 v[88:89], v101 offset:1728
    ds_read_b64_tr_b16 v[90:91], v101 offset:2016
    ds_read_b64_tr_b16 v[92:93], v102 offset:4608
    ds_read_b64_tr_b16 v[94:95], v102 offset:4896
    v_mfma_f32_16x16x32_bf16 v[164:167], a[4:7], a[88:91], v[164:167]
    ds_read_b128 a[68:71], v4 offset:42368
    s_waitcnt lgkmcnt(13)
    v_mfma_f32_16x16x32_bf16 v[168:171], a[4:7], a[92:95], v[168:171]
    ds_read_b128 a[72:75], v4 offset:43392
    v_mfma_f32_16x16x32_bf16 v[172:175], a[4:7], a[96:99], v[172:175]
    ds_read_b128 a[76:79], v4 offset:44416
    s_waitcnt lgkmcnt(11)
    v_mfma_f32_16x16x32_bf16 v[176:179], a[4:7], a[100:103], v[176:179]
    ds_read_b128 a[80:83], v4 offset:45440
    buffer_store_dwordx4 v[76:79], v103, s[28:31], s74 offen sc1
    s_waitcnt lgkmcnt(3)
    v_mfma_f32_16x16x32_bf16 v[160:163], a[8:11], a[64:67], v[160:163]
    ds_read_b128 a[84:87], v4 offset:46464
    v_mfma_f32_16x16x32_bf16 v[164:167], a[8:11], a[68:71], v[164:167]
    ds_read_b128 a[88:91], v4 offset:47488
    s_waitcnt lgkmcnt(3)
    v_mfma_f32_16x16x32_bf16 v[168:171], a[8:11], a[72:75], v[168:171]
    ds_read_b128 a[92:95], v4 offset:48512
    v_mfma_f32_16x16x32_bf16 v[172:175], a[8:11], a[76:79], v[172:175]
    ds_read_b128 a[96:99], v4 offset:49536
    s_waitcnt lgkmcnt(4)
    v_mfma_f32_16x16x32_bf16 v[176:179], a[8:11], a[80:83], v[176:179]
    ds_read_b128 a[100:103], v4 offset:50560
    buffer_store_dwordx4 v[80:83], v103, s[28:31], s75 offen sc1
    s_waitcnt lgkmcnt(3)
    v_mfma_f32_16x16x32_bf16 v[160:163], a[12:15], a[84:87], v[160:163]
    v_mfma_f32_16x16x32_bf16 v[164:167], a[12:15], a[88:91], v[164:167]
    s_waitcnt lgkmcnt(1)
    v_mfma_f32_16x16x32_bf16 v[168:171], a[12:15], a[92:95], v[168:171]
    s_waitcnt vmcnt(21) lgkmcnt(0)
    s_barrier
    ds_read_b128 a[64:67], v5 offset:384
    ds_read_b128 a[68:71], v5 offset:1408
    s_add_u32 m0, s98, 80256
    s_add_u32 s42, s51, 102400
    buffer_load_dwordx4 v2, s[28:31], s42 offen sc1 lds
    v_mfma_f32_16x16x32_bf16 v[172:175], a[12:15], a[96:99], v[172:175]
    ds_read_b128 a[72:75], v5 offset:2432
    ds_read_b128 a[76:79], v5 offset:3456
    v_mfma_f32_16x16x32_bf16 v[176:179], a[12:15], a[100:103], v[176:179]
    ds_read_b128 a[80:83], v5 offset:4480
    buffer_load_dwordx4 v2, s[28:31], s42 offen offset:1024 sc1 lds
    s_waitcnt lgkmcnt(3)
    v_mfma_f32_16x16x32_bf16 v[160:163], a[16:19], a[64:67], v[160:163]
    ds_read_b128 a[84:87], v5 offset:5504
    v_mfma_f32_16x16x32_bf16 v[164:167], a[16:19], a[68:71], v[164:167]
    ds_read_b128 a[88:91], v5 offset:6528
    buffer_load_dwordx4 v2, s[28:31], s42 offen offset:2048 sc1 lds
    s_waitcnt lgkmcnt(3)
    v_mfma_f32_16x16x32_bf16 v[168:171], a[16:19], a[72:75], v[168:171]
    ds_read_b128 a[92:95], v5 offset:7552
    buffer_store_dwordx4 v[84:87], v103, s[28:31], s76 offen sc1
    v_mfma_f32_16x16x32_bf16 v[172:175], a[16:19], a[76:79], v[172:175]
    ds_read_b128 a[96:99], v5 offset:8576
    buffer_load_dwordx4 v2, s[28:31], s42 offen offset:3072 sc1 lds
    s_waitcnt lgkmcnt(4)
    v_mfma_f32_16x16x32_bf16 v[176:179], a[16:19], a[80:83], v[176:179]
    ds_read_b128 a[100:103], v5 offset:9600
    s_waitcnt lgkmcnt(3)
    v_mfma_f32_16x16x32_bf16 v[160:163], a[20:23], a[84:87], v[160:163]
    ds_read_b128 a[64:67], v5 offset:10624
    s_add_u32 m0, s98, 84352
    s_add_u32 s42, s42, 4096
    buffer_load_dwordx4 v2, s[28:31], s42 offen sc1 lds
    v_mfma_f32_16x16x32_bf16 v[164:167], a[20:23], a[88:91], v[164:167]
    ds_read_b128 a[68:71], v5 offset:11648
    s_waitcnt lgkmcnt(3)
    v_mfma_f32_16x16x32_bf16 v[168:171], a[20:23], a[92:95], v[168:171]
    ds_read_b128 a[72:75], v5 offset:12672
    s_add_u32 s45, s44, 16384
    buffer_load_dwordx4 a[0:3], v2, s[28:31], s45 offen sc1
    v_mfma_f32_16x16x32_bf16 v[172:175], a[20:23], a[96:99], v[172:175]
    ds_read_b128 a[76:79], v5 offset:13696
    buffer_store_dwordx4 v[88:91], v103, s[28:31], s77 offen sc1
    s_waitcnt lgkmcnt(4)
    v_mfma_f32_16x16x32_bf16 v[176:179], a[20:23], a[100:103], v[176:179]
    ds_read_b128 a[80:83], v5 offset:14720
    buffer_load_dwordx4 a[4:7], v2, s[28:31], s45 offen offset:1024 sc1
    s_waitcnt lgkmcnt(3)
    v_mfma_f32_16x16x32_bf16 v[160:163], a[24:27], a[64:67], v[160:163]
    ds_read_b128 a[84:87], v5 offset:15744
    v_mfma_f32_16x16x32_bf16 v[164:167], a[24:27], a[68:71], v[164:167]
    ds_read_b128 a[88:91], v5 offset:16768
    buffer_load_dwordx4 a[8:11], v2, s[28:31], s45 offen offset:2048 sc1
    s_waitcnt lgkmcnt(3)
    v_mfma_f32_16x16x32_bf16 v[168:171], a[24:27], a[72:75], v[168:171]
    ds_read_b128 a[92:95], v5 offset:17792
    v_mfma_f32_16x16x32_bf16 v[172:175], a[24:27], a[76:79], v[172:175]
    ds_read_b128 a[96:99], v5 offset:18816
    buffer_load_dwordx4 a[12:15], v2, s[28:31], s45 offen offset:3072 sc1
    s_waitcnt lgkmcnt(4)
    v_mfma_f32_16x16x32_bf16 v[176:179], a[24:27], a[80:83], v[176:179]
    ds_read_b128 a[100:103], v5 offset:19840
    buffer_store_dwordx4 v[92:95], v103, s[28:31], s78 offen sc1
    s_waitcnt lgkmcnt(3)
    v_mfma_f32_16x16x32_bf16 v[160:163], a[28:31], a[84:87], v[160:163]
    v_mfma_f32_16x16x32_bf16 v[164:167], a[28:31], a[88:91], v[164:167]
    s_waitcnt lgkmcnt(1)
    v_mfma_f32_16x16x32_bf16 v[168:171], a[28:31], a[92:95], v[168:171]
    s_waitcnt vmcnt(24) lgkmcnt(0)
    s_barrier
    ds_read_b128 a[64:67], v4 offset:0
    ds_read_b128 a[68:71], v4 offset:1024
    s_add_u32 m0, s98, 100736
    s_add_u32 s42, s51, 122880
    buffer_load_dwordx4 v2, s[28:31], s42 offen sc1 lds
    v_mfma_f32_16x16x32_bf16 v[172:175], a[28:31], a[96:99], v[172:175]
    ds_read_b128 a[72:75], v4 offset:2048
    ds_read_b128 a[76:79], v4 offset:3072
    v_mfma_f32_16x16x32_bf16 v[176:179], a[28:31], a[100:103], v[176:179]
    ds_read_b128 a[80:83], v4 offset:4096
    buffer_load_dwordx4 v2, s[28:31], s42 offen offset:1024 sc1 lds
    s_waitcnt lgkmcnt(3)
    v_mfma_f32_16x16x32_bf16 v[160:163], a[32:35], a[64:67], v[160:163]
    ds_read_b128 a[84:87], v4 offset:5120
    v_mfma_f32_16x16x32_bf16 v[164:167], a[32:35], a[68:71], v[164:167]
    ds_read_b128 a[88:91], v4 offset:6144
    buffer_load_dwordx4 v2, s[28:31], s42 offen offset:2048 sc1 lds
    s_waitcnt lgkmcnt(3)
    v_mfma_f32_16x16x32_bf16 v[168:171], a[32:35], a[72:75], v[168:171]
    ds_read_b128 a[92:95], v4 offset:7168
    v_mfma_f32_16x16x32_bf16 v[172:175], a[32:35], a[76:79], v[172:175]
    ds_read_b128 a[96:99], v4 offset:8192
    buffer_load_dwordx4 v2, s[28:31], s42 offen offset:3072 sc1 lds
    s_waitcnt lgkmcnt(4)
    v_mfma_f32_16x16x32_bf16 v[176:179], a[32:35], a[80:83], v[176:179]
    ds_read_b128 a[100:103], v4 offset:9216
    s_waitcnt lgkmcnt(3)
    v_mfma_f32_16x16x32_bf16 v[160:163], a[36:39], a[84:87], v[160:163]
    ds_read_b128 a[64:67], v4 offset:10240
    s_add_u32 m0, s98, 104832
    s_add_u32 s42, s42, 4096
    buffer_load_dwordx4 v2, s[28:31], s42 offen sc1 lds
    v_mfma_f32_16x16x32_bf16 v[164:167], a[36:39], a[88:91], v[164:167]
    ds_read_b128 a[68:71], v4 offset:11264
    s_waitcnt lgkmcnt(3)
    v_mfma_f32_16x16x32_bf16 v[168:171], a[36:39], a[92:95], v[168:171]
    ds_read_b128 a[72:75], v4 offset:12288
    s_add_u32 s45, s44, 20480
    buffer_load_dwordx4 a[16:19], v2, s[28:31], s45 offen sc1
    v_mfma_f32_16x16x32_bf16 v[172:175], a[36:39], a[96:99], v[172:175]
    ds_read_b128 a[76:79], v4 offset:13312
    s_waitcnt lgkmcnt(4)
    v_mfma_f32_16x16x32_bf16 v[176:179], a[36:39], a[100:103], v[176:179]
    ds_read_b128 a[80:83], v4 offset:14336
    buffer_load_dwordx4 a[20:23], v2, s[28:31], s45 offen offset:1024 sc1
    s_waitcnt lgkmcnt(3)
    v_mfma_f32_16x16x32_bf16 v[160:163], a[40:43], a[64:67], v[160:163]
    ds_read_b128 a[84:87], v4 offset:15360
    v_mfma_f32_16x16x32_bf16 v[164:167], a[40:43], a[68:71], v[164:167]
    ds_read_b128 a[88:91], v4 offset:16384
    buffer_load_dwordx4 a[24:27], v2, s[28:31], s45 offen offset:2048 sc1
    s_waitcnt lgkmcnt(3)
    v_mfma_f32_16x16x32_bf16 v[168:171], a[40:43], a[72:75], v[168:171]
    ds_read_b128 a[92:95], v4 offset:17408
    v_mfma_f32_16x16x32_bf16 v[172:175], a[40:43], a[76:79], v[172:175]
    ds_read_b128 a[96:99], v4 offset:18432
    buffer_load_dwordx4 a[28:31], v2, s[28:31], s45 offen offset:3072 sc1
    s_waitcnt lgkmcnt(4)
    v_mfma_f32_16x16x32_bf16 v[176:179], a[40:43], a[80:83], v[176:179]
    ds_read_b128 a[100:103], v4 offset:19456
    s_waitcnt lgkmcnt(3)
    v_mfma_f32_16x16x32_bf16 v[160:163], a[44:47], a[84:87], v[160:163]
    v_mfma_f32_16x16x32_bf16 v[164:167], a[44:47], a[88:91], v[164:167]
    s_waitcnt lgkmcnt(1)
    v_mfma_f32_16x16x32_bf16 v[168:171], a[44:47], a[92:95], v[168:171]
    s_waitcnt vmcnt(29) lgkmcnt(0)
    s_barrier
    ds_read_b128 a[64:67], v3 offset:0
    ds_read_b128 a[68:71], v3 offset:1024
    buffer_load_dword v231, v8, s[28:31], s79 offen offset:1024 sc1
    v_mfma_f32_16x16x32_bf16 v[172:175], a[44:47], a[96:99], v[172:175]
    ds_read_b128 a[72:75], v3 offset:2048
    ds_read_b128 a[76:79], v3 offset:3072
    s_add_u32 m0, s98, 49152
    s_add_u32 s42, s51, 143360
    buffer_load_dwordx4 v2, s[28:31], s42 offen sc1 lds
    v_mfma_f32_16x16x32_bf16 v[176:179], a[44:47], a[100:103], v[176:179]
    ds_read_b128 a[80:83], v3 offset:4096
    s_waitcnt lgkmcnt(3)
    v_mfma_f32_16x16x32_bf16 v[160:163], a[48:51], a[64:67], v[160:163]
    ds_read_b128 a[84:87], v3 offset:5120
    buffer_load_dwordx4 v2, s[28:31], s42 offen offset:1024 sc1 lds
    v_mfma_f32_16x16x32_bf16 v[164:167], a[48:51], a[68:71], v[164:167]
    ds_read_b128 a[88:91], v3 offset:6144
    s_waitcnt lgkmcnt(3)
    v_mfma_f32_16x16x32_bf16 v[168:171], a[48:51], a[72:75], v[168:171]
    ds_read_b128 a[92:95], v3 offset:7168
    buffer_load_dwordx4 v2, s[28:31], s42 offen offset:2048 sc1 lds
    v_mfma_f32_16x16x32_bf16 v[172:175], a[48:51], a[76:79], v[172:175]
    ds_read_b128 a[96:99], v3 offset:8192
    s_waitcnt lgkmcnt(4)
    v_mfma_f32_16x16x32_bf16 v[176:179], a[48:51], a[80:83], v[176:179]
    ds_read_b128 a[100:103], v3 offset:9216
    buffer_load_dwordx4 v2, s[28:31], s42 offen offset:3072 sc1 lds
    s_waitcnt lgkmcnt(3)
    v_mfma_f32_16x16x32_bf16 v[160:163], a[52:55], a[84:87], v[160:163]
    ds_read_b128 a[64:67], v3 offset:10240
    v_mfma_f32_16x16x32_bf16 v[164:167], a[52:55], a[88:91], v[164:167]
    ds_read_b128 a[68:71], v3 offset:11264
    s_add_u32 m0, s98, 53248
    s_add_u32 s42, s42, 4096
    buffer_load_dwordx4 v2, s[28:31], s42 offen sc1 lds
    s_waitcnt lgkmcnt(3)
    v_mfma_f32_16x16x32_bf16 v[168:171], a[52:55], a[92:95], v[168:171]
    ds_read_b128 a[72:75], v3 offset:12288
    s_add_u32 s45, s44, 24576
    buffer_load_dwordx4 a[32:35], v2, s[28:31], s45 offen sc1
    v_mfma_f32_16x16x32_bf16 v[172:175], a[52:55], a[96:99], v[172:175]
    ds_read_b128 a[76:79], v3 offset:13312
    s_waitcnt lgkmcnt(4)
    v_mfma_f32_16x16x32_bf16 v[176:179], a[52:55], a[100:103], v[176:179]
    ds_read_b128 a[80:83], v3 offset:14336
    buffer_load_dwordx4 a[36:39], v2, s[28:31], s45 offen offset:1024 sc1
    s_waitcnt lgkmcnt(3)
    v_mfma_f32_16x16x32_bf16 v[160:163], a[56:59], a[64:67], v[160:163]
    ds_read_b128 a[84:87], v3 offset:15360
    v_mfma_f32_16x16x32_bf16 v[164:167], a[56:59], a[68:71], v[164:167]
    ds_read_b128 a[88:91], v3 offset:16384
    buffer_load_dwordx4 a[40:43], v2, s[28:31], s45 offen offset:2048 sc1
    s_waitcnt lgkmcnt(3)
    v_mfma_f32_16x16x32_bf16 v[168:171], a[56:59], a[72:75], v[168:171]
    ds_read_b128 a[92:95], v3 offset:17408
    v_mfma_f32_16x16x32_bf16 v[172:175], a[56:59], a[76:79], v[172:175]
    ds_read_b128 a[96:99], v3 offset:18432
    buffer_load_dwordx4 a[44:47], v2, s[28:31], s45 offen offset:3072 sc1
    s_waitcnt lgkmcnt(4)
    v_mfma_f32_16x16x32_bf16 v[176:179], a[56:59], a[80:83], v[176:179]
    ds_read_b128 a[100:103], v3 offset:19456
    s_waitcnt lgkmcnt(3)
    v_mfma_f32_16x16x32_bf16 v[160:163], a[60:63], a[84:87], v[160:163]
    v_mfma_f32_16x16x32_bf16 v[164:167], a[60:63], a[88:91], v[164:167]
    s_waitcnt lgkmcnt(1)
    v_mfma_f32_16x16x32_bf16 v[168:171], a[60:63], a[92:95], v[168:171]
    s_waitcnt vmcnt(20) lgkmcnt(0)
    s_barrier
    ds_read_b128 a[64:67], v3 offset:20480
    ds_read_b128 a[68:71], v3 offset:21504
    s_add_u32 m0, s98, 0
    s_add_u32 s42, s51, 163840
    buffer_load_dwordx4 v2, s[28:31], s42 offen sc1 lds
    v_mfma_f32_16x16x32_bf16 v[172:175], a[60:63], a[96:99], v[172:175]
    ds_read_b128 a[72:75], v3 offset:22528
    ds_read_b128 a[76:79], v3 offset:23552
    v_mfma_f32_16x16x32_bf16 v[176:179], a[60:63], a[100:103], v[176:179]
    ds_read_b128 a[80:83], v3 offset:24576
    buffer_load_dwordx4 v2, s[28:31], s42 offen offset:1024 sc1 lds
    s_waitcnt lgkmcnt(3)
    v_mfma_f32_16x16x32_bf16 v[160:163], a[0:3], a[64:67], v[160:163]
    ds_read_b128 a[84:87], v3 offset:25600
    v_mfma_f32_16x16x32_bf16 v[164:167], a[0:3], a[68:71], v[164:167]
    ds_read_b128 a[88:91], v3 offset:26624
    buffer_load_dwordx4 v2, s[28:31], s42 offen offset:2048 sc1 lds
    s_waitcnt lgkmcnt(3)
    v_mfma_f32_16x16x32_bf16 v[168:171], a[0:3], a[72:75], v[168:171]
    ds_read_b128 a[92:95], v3 offset:27648
    v_mfma_f32_16x16x32_bf16 v[172:175], a[0:3], a[76:79], v[172:175]
    ds_read_b128 a[96:99], v3 offset:28672
    buffer_load_dwordx4 v2, s[28:31], s42 offen offset:3072 sc1 lds
    s_waitcnt lgkmcnt(4)
    v_mfma_f32_16x16x32_bf16 v[176:179], a[0:3], a[80:83], v[176:179]
    ds_read_b128 a[100:103], v3 offset:29696
    s_waitcnt lgkmcnt(3)
    v_mfma_f32_16x16x32_bf16 v[160:163], a[4:7], a[84:87], v[160:163]
    ds_read_b128 a[64:67], v3 offset:30720
    s_add_u32 m0, s98, 4096
    s_add_u32 s42, s42, 4096
    buffer_load_dwordx4 v2, s[28:31], s42 offen sc1 lds
    v_mfma_f32_16x16x32_bf16 v[164:167], a[4:7], a[88:91], v[164:167]
    ds_read_b128 a[68:71], v3 offset:31744
    s_waitcnt lgkmcnt(3)
    v_mfma_f32_16x16x32_bf16 v[168:171], a[4:7], a[92:95], v[168:171]
    ds_read_b128 a[72:75], v3 offset:32768
    s_add_u32 s45, s44, 28672
    buffer_load_dwordx4 a[48:51], v2, s[28:31], s45 offen sc1
    v_mfma_f32_16x16x32_bf16 v[172:175], a[4:7], a[96:99], v[172:175]
    ds_read_b128 a[76:79], v3 offset:33792
    s_waitcnt lgkmcnt(4)
    v_mfma_f32_16x16x32_bf16 v[176:179], a[4:7], a[100:103], v[176:179]
    ds_read_b128 a[80:83], v3 offset:34816
    buffer_load_dwordx4 a[52:55], v2, s[28:31], s45 offen offset:1024 sc1
    s_waitcnt lgkmcnt(3)
    v_mfma_f32_16x16x32_bf16 v[160:163], a[8:11], a[64:67], v[160:163]
    ds_read_b128 a[84:87], v3 offset:35840
    v_mfma_f32_16x16x32_bf16 v[164:167], a[8:11], a[68:71], v[164:167]
    ds_read_b128 a[88:91], v3 offset:36864
    buffer_load_dwordx4 a[56:59], v2, s[28:31], s45 offen offset:2048 sc1
    s_waitcnt lgkmcnt(3)
    v_mfma_f32_16x16x32_bf16 v[168:171], a[8:11], a[72:75], v[168:171]
    ds_read_b128 a[92:95], v3 offset:37888
    v_mfma_f32_16x16x32_bf16 v[172:175], a[8:11], a[76:79], v[172:175]
    ds_read_b128 a[96:99], v3 offset:38912
    buffer_load_dwordx4 a[60:63], v2, s[28:31], s45 offen offset:3072 sc1
    s_waitcnt lgkmcnt(4)
    v_mfma_f32_16x16x32_bf16 v[176:179], a[8:11], a[80:83], v[176:179]
    ds_read_b128 a[100:103], v3 offset:39936
    s_waitcnt lgkmcnt(3)
    v_mfma_f32_16x16x32_bf16 v[160:163], a[12:15], a[84:87], v[160:163]
    v_mfma_f32_16x16x32_bf16 v[164:167], a[12:15], a[88:91], v[164:167]
    s_waitcnt lgkmcnt(1)
    v_mfma_f32_16x16x32_bf16 v[168:171], a[12:15], a[92:95], v[168:171]
    s_waitcnt vmcnt(18)
    s_cmp_lg_u32 s4, 0
    s_cbranch_scc1 SPD_20
    s_mov_b32 s60, 40000
SP_19:
    v_cmp_ne_u32 s[100:101], s50, v231
    s_nop 0
    s_cmp_eq_u64 s[100:101], 0
    s_cbranch_scc1 SPD_20
    s_sub_u32 s60, s60, 1
    s_cmp_eq_u32 s60, 0
    s_cbranch_scc1 SPD_20
    s_sleep 4
    buffer_load_dword v231, v8, s[28:31], s79 offen offset:1024 sc1
    s_waitcnt vmcnt(0)
    s_branch SP_19
SPD_20:
    s_waitcnt lgkmcnt(0)
    s_barrier
    s_mov_b64 exec, 1
    buffer_store_dword a255, off, s[28:31], s72 sc0 sc1
    s_mov_b64 exec, -1
    ds_read_b128 a[64:67], v4 offset:31104
    ds_read_b128 a[68:71], v4 offset:32128
    s_add_u32 m0, s98, 20480
    s_add_u32 s42, s51, 184320
    buffer_load_dwordx4 v2, s[28:31], s42 offen sc1 lds
    v_mfma_f32_16x16x32_bf16 v[172:175], a[12:15], a[96:99], v[172:175]
    ds_read_b128 a[72:75], v4 offset:33152
    ds_read_b128 a[76:79], v4 offset:34176
    v_mfma_f32_16x16x32_bf16 v[176:179], a[12:15], a[100:103], v[176:179]
    ds_read_b128 a[80:83], v4 offset:35200
    buffer_load_dwordx4 v2, s[28:31], s42 offen offset:1024 sc1 lds
    s_waitcnt lgkmcnt(3)
    v_mfma_f32_16x16x32_bf16 v[160:163], a[16:19], a[64:67], v[160:163]
    ds_read_b128 a[84:87], v4 offset:36224
    v_mfma_f32_16x16x32_bf16 v[164:167], a[16:19], a[68:71], v[164:167]
    ds_read_b128 a[88:91], v4 offset:37248
    buffer_load_dwordx4 v2, s[28:31], s42 offen offset:2048 sc1 lds
    s_waitcnt lgkmcnt(3)
    v_mfma_f32_16x16x32_bf16 v[168:171], a[16:19], a[72:75], v[168:171]
    ds_read_b128 a[92:95], v4 offset:38272
    v_mfma_f32_16x16x32_bf16 v[172:175], a[16:19], a[76:79], v[172:175]
    ds_read_b128 a[96:99], v4 offset:39296
    buffer_load_dwordx4 v2, s[28:31], s42 offen offset:3072 sc1 lds
    s_waitcnt lgkmcnt(4)
    v_mfma_f32_16x16x32_bf16 v[176:179], a[16:19], a[80:83], v[176:179]
    ds_read_b128 a[100:103], v4 offset:40320
    s_waitcnt lgkmcnt(3)
    v_mfma_f32_16x16x32_bf16 v[160:163], a[20:23], a[84:87], v[160:163]
    ds_read_b128 a[64:67], v4 offset:41344
    s_add_u32 m0, s98, 24576
    s_add_u32 s42, s42, 4096
    buffer_load_dwordx4 v2, s[28:31], s42 offen sc1 lds
    v_mfma_f32_16x16x32_bf16 v[164:167], a[20:23], a[88:91], v[164:167]
    ds_read_b128 a[68:71], v4 offset:42368
    s_waitcnt lgkmcnt(3)
    v_mfma_f32_16x16x32_bf16 v[168:171], a[20:23], a[92:95], v[168:171]
    ds_read_b128 a[72:75], v4 offset:43392
    s_add_u32 s45, s44, 32768
    buffer_load_dwordx4 a[0:3], v2, s[28:31], s45 offen sc1
    v_mfma_f32_16x16x32_bf16 v[172:175], a[20:23], a[96:99], v[172:175]
    ds_read_b128 a[76:79], v4 offset:44416
    s_waitcnt lgkmcnt(4)
    v_mfma_f32_16x16x32_bf16 v[176:179], a[20:23], a[100:103], v[176:179]
    ds_read_b128 a[80:83], v4 offset:45440
    buffer_load_dwordx4 a[4:7], v2, s[28:31], s45 offen offset:1024 sc1
    s_waitcnt lgkmcnt(3)
    v_mfma_f32_16x16x32_bf16 v[160:163], a[24:27], a[64:67], v[160:163]
    ds_read_b128 a[84:87], v4 offset:46464
    v_mfma_f32_16x16x32_bf16 v[164:167], a[24:27], a[68:71], v[164:167]
    ds_read_b128 a[88:91], v4 offset:47488
    buffer_load_dwordx4 a[8:11], v2, s[28:31], s45 offen offset:2048 sc1
    s_waitcnt lgkmcnt(3)
    v_mfma_f32_16x16x32_bf16 v[168:171], a[24:27], a[72:75], v[168:171]
    ds_read_b128 a[92:95], v4 offset:48512
    v_mfma_f32_16x16x32_bf16 v[172:175], a[24:27], a[76:79], v[172:175]
    ds_read_b128 a[96:99], v4 offset:49536
    buffer_load_dwordx4 a[12:15], v2, s[28:31], s45 offen offset:3072 sc1
    s_waitcnt lgkmcnt(4)
    v_mfma_f32_16x16x32_bf16 v[176:179], a[24:27], a[80:83], v[176:179]
    ds_read_b128 a[100:103], v4 offset:50560
    s_waitcnt lgkmcnt(3)
    v_mfma_f32_16x16x32_bf16 v[160:163], a[28:31], a[84:87], v[160:163]
    v_mfma_f32_16x16x32_bf16 v[164:167], a[28:31], a[88:91], v[164:167]
    s_waitcnt lgkmcnt(1)
    v_mfma_f32_16x16x32_bf16 v[168:171], a[28:31], a[92:95], v[168:171]
    s_waitcnt vmcnt(19) lgkmcnt(0)
    s_barrier
    ds_read_b128 a[64:67], v5 offset:384
    ds_read_b128 a[68:71], v5 offset:1408
    s_add_u32 m0, s98, 80256
    s_add_u32 s42, s51, 204800
    buffer_load_dwordx4 v2, s[28:31], s42 offen sc1 lds
    v_mfma_f32_16x16x32_bf16 v[172:175], a[28:31], a[96:99], v[172:175]
    ds_read_b128 a[72:75], v5 offset:2432
    ds_read_b128 a[76:79], v5 offset:3456
    v_mfma_f32_16x16x32_bf16 v[176:179], a[28:31], a[100:103], v[176:179]
    ds_read_b128 a[80:83], v5 offset:4480
    buffer_load_dwordx4 v2, s[28:31], s42 offen offset:1024 sc1 lds
    s_waitcnt lgkmcnt(3)
    v_mfma_f32_16x16x32_bf16 v[160:163], a[32:35], a[64:67], v[160:163]
    ds_read_b128 a[84:87], v5 offset:5504
    v_mfma_f32_16x16x32_bf16 v[164:167], a[32:35], a[68:71], v[164:167]
    ds_read_b128 a[88:91], v5 offset:6528
    buffer_load_dwordx4 v2, s[28:31], s42 offen offset:2048 sc1 lds
    s_waitcnt lgkmcnt(3)
    v_mfma_f32_16x16x32_bf16 v[168:171], a[32:35], a[72:75], v[168:171]
    ds_read_b128 a[92:95], v5 offset:7552
    v_mfma_f32_16x16x32_bf16 v[172:175], a[32:35], a[76:79], v[172:175]
    ds_read_b128 a[96:99], v5 offset:8576
    buffer_load_dwordx4 v2, s[28:31], s42 offen offset:3072 sc1 lds
    s_waitcnt lgkmcnt(4)
    v_mfma_f32_16x16x32_bf16 v[176:179], a[32:35], a[80:83], v[176:179]
    ds_read_b128 a[100:103], v5 offset:9600
    s_waitcnt lgkmcnt(3)
    v_mfma_f32_16x16x32_bf16 v[160:163], a[36:39], a[84:87], v[160:163]
    ds_read_b128 a[64:67], v5 offset:10624
    s_add_u32 m0, s98, 84352
    s_add_u32 s42, s42, 4096
    buffer_load_dwordx4 v2, s[28:31], s42 offen sc1 lds
    v_mfma_f32_16x16x32_bf16 v[164:167], a[36:39], a[88:91], v[164:167]
    ds_read_b128 a[68:71], v5 offset:11648
    s_waitcnt lgkmcnt(3)
    v_mfma_f32_16x16x32_bf16 v[168:171], a[36:39], a[92:95], v[168:171]
    ds_read_b128 a[72:75], v5 offset:12672
    s_add_u32 s45, s44, 36864
    buffer_load_dwordx4 a[16:19], v2, s[28:31], s45 offen sc1
    v_mfma_f32_16x16x32_bf16 v[172:175], a[36:39], a[96:99], v[172:175]
    ds_read_b128 a[76:79], v5 offset:13696
    s_waitcnt lgkmcnt(4)
    v_mfma_f32_16x16x32_bf16 v[176:179], a[36:39], a[100:103], v[176:179]
    ds_read_b128 a[80:83], v5 offset:14720
    buffer_load_dwordx4 a[20:23], v2, s[28:31], s45 offen offset:1024 sc1
    s_waitcnt lgkmcnt(3)
    v_mfma_f32_16x16x32_bf16 v[160:163], a[40:43], a[64:67], v[160:163]
    ds_read_b128 a[84:87], v5 offset:15744
    v_mfma_f32_16x16x32_bf16 v[164:167], a[40:43], a[68:71], v[164:167]
    ds_read_b128 a[88:91], v5 offset:16768
    buffer_load_dwordx4 a[24:27], v2, s[28:31], s45 offen offset:2048 sc1
    s_waitcnt lgkmcnt(3)
    v_mfma_f32_16x16x32_bf16 v[168:171], a[40:43], a[72:75], v[168:171]
    ds_read_b128 a[92:95], v5 offset:17792
    v_mfma_f32_16x16x32_bf16 v[172:175], a[40:43], a[76:79], v[172:175]
    ds_read_b128 a[96:99], v5 offset:18816
    buffer_load_dwordx4 a[28:31], v2, s[28:31], s45 offen offset:3072 sc1
    s_waitcnt lgkmcnt(4)
    v_mfma_f32_16x16x32_bf16 v[176:179], a[40:43], a[80:83], v[176:179]
    ds_read_b128 a[100:103], v5 offset:19840
    s_waitcnt lgkmcnt(3)
    v_mfma_f32_16x16x32_bf16 v[160:163], a[44:47], a[84:87], v[160:163]
    v_mfma_f32_16x16x32_bf16 v[164:167], a[44:47], a[88:91], v[164:167]
    s_waitcnt lgkmcnt(1)
    v_mfma_f32_16x16x32_bf16 v[168:171], a[44:47], a[92:95], v[168:171]
    s_waitcnt vmcnt(19) lgkmcnt(0)
    s_barrier
    ds_read_b128 a[64:67], v4 offset:0
    ds_read_b128 a[68:71], v4 offset:1024
    s_add_u32 m0, s98, 100736
    s_add_u32 s42, s51, 225280
    buffer_load_dwordx4 v2, s[28:31], s42 offen sc1 lds
    v_mfma_f32_16x16x32_bf16 v[172:175], a[44:47], a[96:99], v[172:175]
    ds_read_b128 a[72:75], v4 offset:2048
    ds_read_b128 a[76:79], v4 offset:3072
    v_mfma_f32_16x16x32_bf16 v[176:179], a[44:47], a[100:103], v[176:179]
    ds_read_b128 a[80:83], v4 offset:4096
    buffer_load_dwordx4 v2, s[28:31], s42 offen offset:1024 sc1 lds
    s_waitcnt lgkmcnt(3)
    v_mfma_f32_16x16x32_bf16 v[160:163], a[48:51], a[64:67], v[160:163]
    ds_read_b128 a[84:87], v4 offset:5120
    v_mfma_f32_16x16x32_bf16 v[164:167], a[48:51], a[68:71], v[164:167]
    ds_read_b128 a[88:91], v4 offset:6144
    buffer_load_dwordx4 v2, s[28:31], s42 offen offset:2048 sc1 lds
    s_waitcnt lgkmcnt(3)
    v_mfma_f32_16x16x32_bf16 v[168:171], a[48:51], a[72:75], v[168:171]
    ds_read_b128 a[92:95], v4 offset:7168
    v_mfma_f32_16x16x32_bf16 v[172:175], a[48:51], a[76:79], v[172:175]
    ds_read_b128 a[96:99], v4 offset:8192
    buffer_load_dwordx4 v2, s[28:31], s42 offen offset:3072 sc1 lds
    s_waitcnt lgkmcnt(4)
    v_mfma_f32_16x16x32_bf16 v[176:179], a[48:51], a[80:83], v[176:179]
    ds_read_b128 a[100:103], v4 offset:9216
    s_waitcnt lgkmcnt(3)
    v_mfma_f32_16x16x32_bf16 v[160:163], a[52:55], a[84:87], v[160:163]
    ds_read_b128 a[64:67], v4 offset:10240
    s_add_u32 m0, s98, 104832
    s_add_u32 s42, s42, 4096
    buffer_load_dwordx4 v2, s[28:31], s42 offen sc1 lds
    v_mfma_f32_16x16x32_bf16 v[164:167], a[52:55], a[88:91], v[164:167]
    ds_read_b128 a[68:71], v4 offset:11264
    s_waitcnt lgkmcnt(3)
    v_mfma_f32_16x16x32_bf16 v[168:171], a[52:55], a[92:95], v[168:171]
    ds_read_b128 a[72:75], v4 offset:12288
    s_add_u32 s45, s44, 40960
    buffer_load_dwordx4 a[32:35], v2, s[28:31], s45 offen sc1
    v_mfma_f32_16x16x32_bf16 v[172:175], a[52:55], a[96:99], v[172:175]
    ds_read_b128 a[76:79], v4 offset:13312
    s_waitcnt lgkmcnt(4)
    v_mfma_f32_16x16x32_bf16 v[176:179], a[52:55], a[100:103], v[176:179]
    ds_read_b128 a[80:83], v4 offset:14336
    buffer_load_dwordx4 a[36:39], v2, s[28:31], s45 offen offset:1024 sc1
    s_waitcnt lgkmcnt(3)
    v_mfma_f32_16x16x32_bf16 v[160:163], a[56:59], a[64:67], v[160:163]
    ds_read_b128 a[84:87], v4 offset:15360
    v_mfma_f32_16x16x32_bf16 v[164:167], a[56:59], a[68:71], v[164:167]
    ds_read_b128 a[88:91], v4 offset:16384
    buffer_load_dwordx4 a[40:43], v2, s[28:31], s45 offen offset:2048 sc1
    s_waitcnt lgkmcnt(3)
    v_mfma_f32_16x16x32_bf16 v[168:171], a[56:59], a[72:75], v[168:171]
    ds_read_b128 a[92:95], v4 offset:17408
    v_mfma_f32_16x16x32_bf16 v[172:175], a[56:59], a[76:79], v[172:175]
    ds_read_b128 a[96:99], v4 offset:18432
    buffer_load_dwordx4 a[44:47], v2, s[28:31], s45 offen offset:3072 sc1
    s_waitcnt lgkmcnt(4)
    v_mfma_f32_16x16x32_bf16 v[176:179], a[56:59], a[80:83], v[176:179]
    ds_read_b128 a[100:103], v4 offset:19456
    s_waitcnt lgkmcnt(3)
    v_mfma_f32_16x16x32_bf16 v[160:163], a[60:63], a[84:87], v[160:163]
    v_mfma_f32_16x16x32_bf16 v[164:167], a[60:63], a[88:91], v[164:167]
    s_waitcnt lgkmcnt(1)
    v_mfma_f32_16x16x32_bf16 v[168:171], a[60:63], a[92:95], v[168:171]
    s_waitcnt vmcnt(18) lgkmcnt(0)
    s_barrier
    ds_read_b128 a[64:67], v3 offset:0
    ds_read_b128 a[68:71], v3 offset:1024
    buffer_load_dword v231, v8, s[28:31], s79 offen offset:2048 sc1
    v_mfma_f32_16x16x32_bf16 v[172:175], a[60:63], a[96:99], v[172:175]
    ds_read_b128 a[72:75], v3 offset:2048
    ds_read_b128 a[76:79], v3 offset:3072
    s_add_u32 m0, s98, 49152
    s_add_u32 s42, s51, 245760
    buffer_load_dwordx4 v2, s[28:31], s42 offen sc1 lds
    v_mfma_f32_16x16x32_bf16 v[176:179], a[60:63], a[100:103], v[176:179]
    ds_read_b128 a[80:83], v3 offset:4096
    s_getpc_b64 s[52:53]
TB_21:
    s_add_u32 s52, s52, LANETAB+3072-TB_21
    s_addc_u32 s53, s53, 0
    global_load_dwordx4 v[200:203], v2, s[52:53] offset:0
    s_waitcnt lgkmcnt(3)
    v_mfma_f32_16x16x32_bf16 v[160:163], a[0:3], a[64:67], v[160:163]
    ds_read_b128 a[84:87], v3 offset:5120
    buffer_load_dwordx4 v2, s[28:31], s42 offen offset:1024 sc1 lds
    v_mfma_f32_16x16x32_bf16 v[164:167], a[0:3], a[68:71], v[164:167]
    ds_read_b128 a[88:91], v3 offset:6144
    s_waitcnt lgkmcnt(3)
    v_mfma_f32_16x16x32_bf16 v[168:171], a[0:3], a[72:75], v[168:171]
    ds_read_b128 a[92:95], v3 offset:7168
    buffer_load_dwordx4 v2, s[28:31], s42 offen offset:2048 sc1 lds
    v_mfma_f32_16x16x32_bf16 v[172:175], a[0:3], a[76:79], v[172:175]
    ds_read_b128 a[96:99], v3 offset:8192
    global_load_dwordx4 v[208:211], v2, s[52:53] offset:1024
    s_waitcnt lgkmcnt(4)
    v_mfma_f32_16x16x32_bf16 v[176:179], a[0:3], a[80:83], v[176:179]
    ds_read_b128 a[100:103], v3 offset:9216
    buffer_load_dwordx4 v2, s[28:31], s42 offen offset:3072 sc1 lds
    s_waitcnt lgkmcnt(3)
    v_mfma_f32_16x16x32_bf16 v[160:163], a[4:7], a[84:87], v[160:163]
    ds_read_b128 a[64:67], v3 offset:10240
    s_mov_b32 s32, s80
    s_and_b32 s33, s81, 0xffff
    s_mov_b32 s34, 1280
    s_mov_b32 s35, 0x20000
    v_mfma_f32_16x16x32_bf16 v[164:167], a[4:7], a[88:91], v[164:167]
    ds_read_b128 a[68:71], v3 offset:11264
    s_add_u32 m0, s98, 53248
    s_add_u32 s42, s42, 4096
    buffer_load_dwordx4 v2, s[28:31], s42 offen sc1 lds
    s_waitcnt lgkmcnt(3)
    v_mfma_f32_16x16x32_bf16 v[168:171], a[4:7], a[92:95], v[168:171]
    ds_read_b128 a[72:75], v3 offset:12288
    s_add_u32 s45, s44, 45056
    buffer_load_dwordx4 a[48:51], v2, s[28:31], s45 offen sc1
    v_mfma_f32_16x16x32_bf16 v[172:175], a[4:7], a[96:99], v[172:175]
    ds_read_b128 a[76:79], v3 offset:13312
    s_lshl_b32 s52, s3, 6
    s_lshr_b32 s53, s4, 1
    s_lshl_b32 s53, s53, 5
    s_add_u32 s52, s52, s53
    s_waitcnt lgkmcnt(4)
    v_mfma_f32_16x16x32_bf16 v[176:179], a[4:7], a[100:103], v[176:179]
    ds_read_b128 a[80:83], v3 offset:14336
    buffer_load_dwordx4 a[52:55], v2, s[28:31], s45 offen offset:1024 sc1
    s_waitcnt lgkmcnt(3)
    v_mfma_f32_16x16x32_bf16 v[160:163], a[8:11], a[64:67], v[160:163]
    ds_read_b128 a[84:87], v3 offset:15360
    s_and_b32 s53, s4, 1
    s_lshl_b32 s53, s53, 3
    s_add_u32 s52, s52, s53
    s_mul_i32 s54, s52, 1280
    s_mul_i32 s53, s7, 160
    s_add_u32 s54, s54, s53
    v_mfma_f32_16x16x32_bf16 v[164:167], a[8:11], a[68:71], v[164:167]
    ds_read_b128 a[88:91], v3 offset:16384
    buffer_load_dwordx4 a[56:59], v2, s[28:31], s45 offen offset:2048 sc1
    s_waitcnt lgkmcnt(3)
    v_mfma_f32_16x16x32_bf16 v[168:171], a[8:11], a[72:75], v[168:171]
    ds_read_b128 a[92:95], v3 offset:17408
    s_mul_i32 s57, s4, 2816
    s_add_u32 s57, s57, 129408
    s_mul_i32 s53, s7, 80
    v_mfma_f32_16x16x32_bf16 v[172:175], a[8:11], a[76:79], v[172:175]
    ds_read_b128 a[96:99], v3 offset:18432
    buffer_load_dwordx4 a[60:63], v2, s[28:31], s45 offen offset:3072 sc1
    s_waitcnt lgkmcnt(4)
    v_mfma_f32_16x16x32_bf16 v[176:179], a[8:11], a[80:83], v[176:179]
    ds_read_b128 a[100:103], v3 offset:19456
    s_waitcnt lgkmcnt(3)
    v_mfma_f32_16x16x32_bf16 v[160:163], a[12:15], a[84:87], v[160:163]
    v_mfma_f32_16x16x32_bf16 v[164:167], a[12:15], a[88:91], v[164:167]
    s_waitcnt lgkmcnt(1)
    v_mfma_f32_16x16x32_bf16 v[168:171], a[12:15], a[92:95], v[168:171]
    s_waitcnt vmcnt(21) lgkmcnt(0)
    s_barrier
    ds_read_b128 a[64:67], v3 offset:20480
    ds_read_b128 a[68:71], v3 offset:21504
    s_add_u32 m0, s98, 0
    s_add_u32 s42, s51, 266240
    buffer_load_dwordx4 v2, s[28:31], s42 offen sc1 lds
    v_mfma_f32_16x16x32_bf16 v[172:175], a[12:15], a[96:99], v[172:175]
    ds_read_b128 a[72:75], v3 offset:22528
    ds_read_b128 a[76:79], v3 offset:23552
    v_mfma_f32_16x16x32_bf16 v[176:179], a[12:15], a[100:103], v[176:179]
    ds_read_b128 a[80:83], v3 offset:24576
    s_waitcnt lgkmcnt(3)
    v_mfma_f32_16x16x32_bf16 v[160:163], a[16:19], a[64:67], v[160:163]
    ds_read_b128 a[84:87], v3 offset:25600
    buffer_load_dwordx4 v2, s[28:31], s42 offen offset:1024 sc1 lds
    v_mfma_f32_16x16x32_bf16 v[164:167], a[16:19], a[68:71], v[164:167]
    ds_read_b128 a[88:91], v3 offset:26624
    s_waitcnt lgkmcnt(3)
    v_mfma_f32_16x16x32_bf16 v[168:171], a[16:19], a[72:75], v[168:171]
    ds_read_b128 a[92:95], v3 offset:27648
    v_mfma_f32_16x16x32_bf16 v[172:175], a[16:19], a[76:79], v[172:175]
    ds_read_b128 a[96:99], v3 offset:28672
    s_waitcnt lgkmcnt(4)
    v_mfma_f32_16x16x32_bf16 v[176:179], a[16:19], a[80:83], v[176:179]
    ds_read_b128 a[100:103], v3 offset:29696
    buffer_load_dwordx4 v2, s[28:31], s42 offen offset:2048 sc1 lds
    s_waitcnt lgkmcnt(3)
    v_mfma_f32_16x16x32_bf16 v[160:163], a[20:23], a[84:87], v[160:163]
    ds_read_b128 a[64:67], v3 offset:30720
    v_mfma_f32_16x16x32_bf16 v[164:167], a[20:23], a[88:91], v[164:167]
    ds_read_b128 a[68:71], v3 offset:31744
    s_waitcnt lgkmcnt(3)
    v_mfma_f32_16x16x32_bf16 v[168:171], a[20:23], a[92:95], v[168:171]
    ds_read_b128 a[72:75], v3 offset:32768
    buffer_load_dwordx4 v2, s[28:31], s42 offen offset:3072 sc1 lds
    v_mfma_f32_16x16x32_bf16 v[172:175], a[20:23], a[96:99], v[172:175]
    ds_read_b128 a[76:79], v3 offset:33792
    s_waitcnt lgkmcnt(4)
    v_mfma_f32_16x16x32_bf16 v[176:179], a[20:23], a[100:103], v[176:179]
    ds_read_b128 a[80:83], v3 offset:34816
    s_waitcnt lgkmcnt(3)
    v_mfma_f32_16x16x32_bf16 v[160:163], a[24:27], a[64:67], v[160:163]
    ds_read_b128 a[84:87], v3 offset:35840
    v_mfma_f32_16x16x32_bf16 v[164:167], a[24:27], a[68:71], v[164:167]
    ds_read_b128 a[88:91], v3 offset:36864
    s_add_u32 m0, s98, 4096
    s_add_u32 s42, s42, 4096
    buffer_load_dwordx4 v2, s[28:31], s42 offen sc1 lds
    s_waitcnt lgkmcnt(3)
    v_mfma_f32_16x16x32_bf16 v[168:171], a[24:27], a[72:75], v[168:171]
    ds_read_b128 a[92:95], v3 offset:37888
    v_mfma_f32_16x16x32_bf16 v[172:175], a[24:27], a[76:79], v[172:175]
    ds_read_b128 a[96:99], v3 offset:38912
    s_waitcnt lgkmcnt(4)
    v_mfma_f32_16x16x32_bf16 v[176:179], a[24:27], a[80:83], v[176:179]
    ds_read_b128 a[100:103], v3 offset:39936
    s_waitcnt lgkmcnt(3)
    v_mfma_f32_16x16x32_bf16 v[160:163], a[28:31], a[84:87], v[160:163]
    v_mfma_f32_16x16x32_bf16 v[164:167], a[28:31], a[88:91], v[164:167]
    s_waitcnt lgkmcnt(1)
    v_mfma_f32_16x16x32_bf16 v[168:171], a[28:31], a[92:95], v[168:171]
    s_waitcnt vmcnt(16)
    s_cmp_lg_u32 s4, 0
    s_cbranch_scc1 SPD_23
    s_mov_b32 s60, 40000
SP_22:
    v_cmp_ne_u32 s[100:101], s50, v231
    s_nop 0
    s_cmp_eq_u64 s[100:101], 0
    s_cbranch_scc1 SPD_23
    s_sub_u32 s60, s60, 1
    s_cmp_eq_u32 s60, 0
    s_cbranch_scc1 SPD_23
    s_sleep 4
    buffer_load_dword v231, v8, s[28:31], s79 offen offset:2048 sc1
    s_waitcnt vmcnt(0)
    s_branch SP_22
SPD_23:
    s_waitcnt lgkmcnt(0)
    s_barrier
    ds_read_b128 a[64:67], v4 offset:31104
    ds_read_b128 a[68:71], v4 offset:32128
    s_add_u32 m0, s98, 20480
    s_add_u32 s42, s51, 286720
    buffer_load_dwordx4 v2, s[28:31], s42 offen sc1 lds
    v_mfma_f32_16x16x32_bf16 v[172:175], a[28:31], a[96:99], v[172:175]
    ds_read_b128 a[72:75], v4 offset:33152
    ds_read_b128 a[76:79], v4 offset:34176
    buffer_load_dwordx4 v2, s[28:31], s42 offen offset:1024 sc1 lds
    v_mfma_f32_16x16x32_bf16 v[176:179], a[28:31], a[100:103], v[176:179]
    ds_read_b128 a[80:83], v4 offset:35200
    buffer_load_dwordx4 v2, s[28:31], s42 offen offset:2048 sc1 lds
    s_waitcnt lgkmcnt(3)
    v_mfma_f32_16x16x32_bf16 v[160:163], a[32:35], a[64:67], v[160:163]
    ds_read_b128 a[84:87], v4 offset:36224
    s_waitcnt vmcnt(14)
    v_add_u32 v6, s52, v203
    v_add_u32 v7, s53, v208
    v_add_u32 v229, s57, v209
    v_add_u32_e64 v230, s57, v210
    v_mfma_f32_16x16x32_bf16 v[164:167], a[32:35], a[68:71], v[164:167]
    ds_read_b128 a[88:91], v4 offset:37248
    buffer_load_dwordx4 v2, s[28:31], s42 offen offset:3072 sc1 lds
    s_waitcnt lgkmcnt(3)
    v_mfma_f32_16x16x32_bf16 v[168:171], a[32:35], a[72:75], v[168:171]
    ds_read_b128 a[92:95], v4 offset:38272
    s_add_u32 m0, s98, 24576
    s_add_u32 s42, s42, 4096
    buffer_load_dwordx4 v2, s[28:31], s42 offen sc1 lds
    v_mfma_f32_16x16x32_bf16 v[172:175], a[32:35], a[76:79], v[172:175]
    ds_read_b128 a[96:99], v4 offset:39296
    s_add_u32 s45, s44, 49152
    buffer_load_dwordx4 a[0:3], v2, s[28:31], s45 offen sc1
    s_waitcnt lgkmcnt(4)
    v_mfma_f32_16x16x32_bf16 v[176:179], a[32:35], a[80:83], v[176:179]
    ds_read_b128 a[100:103], v4 offset:40320
    v_add_u32 v204, s54, v200
    v_add_u32 v205, s54, v201
    v_add_u32 v206, s54, v202
    s_waitcnt lgkmcnt(3)
    v_mfma_f32_16x16x32_bf16 v[160:163], a[36:39], a[84:87], v[160:163]
    ds_read_b128 a[64:67], v4 offset:41344
    buffer_load_dwordx4 a[4:7], v2, s[28:31], s45 offen offset:1024 sc1
    v_mfma_f32_16x16x32_bf16 v[164:167], a[36:39], a[88:91], v[164:167]
    ds_read_b128 a[68:71], v4 offset:42368
    buffer_load_dwordx4 a[8:11], v2, s[28:31], s45 offen offset:2048 sc1
    s_waitcnt lgkmcnt(3)
    v_mfma_f32_16x16x32_bf16 v[168:171], a[36:39], a[92:95], v[168:171]
    ds_read_b128 a[72:75], v4 offset:43392
    v_mfma_f32_16x16x32_bf16 v[172:175], a[36:39], a[96:99], v[172:175]
    ds_read_b128 a[76:79], v4 offset:44416
    buffer_load_dwordx4 a[12:15], v2, s[28:31], s45 offen offset:3072 sc1
    s_waitcnt lgkmcnt(4)
    v_mfma_f32_16x16x32_bf16 v[176:179], a[36:39], a[100:103], v[176:179]
    ds_read_b128 a[80:83], v4 offset:45440
    s_add_u32 s45, s44, 53248
    buffer_load_dwordx4 a[16:19], v2, s[28:31], s45 offen sc1
    s_waitcnt lgkmcnt(3)
    v_mfma_f32_16x16x32_bf16 v[160:163], a[40:43], a[64:67], v[160:163]
    ds_read_b128 a[84:87], v4 offset:46464
    buffer_load_dwordx4 a[20:23], v2, s[28:31], s45 offen offset:1024 sc1
    v_mfma_f32_16x16x32_bf16 v[164:167], a[40:43], a[68:71], v[164:167]
    ds_read_b128 a[88:91], v4 offset:47488
    s_waitcnt lgkmcnt(3)
    v_mfma_f32_16x16x32_bf16 v[168:171], a[40:43], a[72:75], v[168:171]
    ds_read_b128 a[92:95], v4 offset:48512
    buffer_load_dwordx4 a[24:27], v2, s[28:31], s45 offen offset:2048 sc1
    v_mfma_f32_16x16x32_bf16 v[172:175], a[40:43], a[76:79], v[172:175]
    ds_read_b128 a[96:99], v4 offset:49536
    buffer_load_dwordx4 a[28:31], v2, s[28:31], s45 offen offset:3072 sc1
    s_waitcnt lgkmcnt(4)
    v_mfma_f32_16x16x32_bf16 v[176:179], a[40:43], a[80:83], v[176:179]
    ds_read_b128 a[100:103], v4 offset:50560
    s_waitcnt lgkmcnt(3)
    v_mfma_f32_16x16x32_bf16 v[160:163], a[44:47], a[84:87], v[160:163]
    v_mfma_f32_16x16x32_bf16 v[164:167], a[44:47], a[88:91], v[164:167]
    s_waitcnt lgkmcnt(1)
    v_mfma_f32_16x16x32_bf16 v[168:171], a[44:47], a[92:95], v[168:171]
    s_waitcnt vmcnt(18) lgkmcnt(0)
    s_barrier
    s_mov_b32 m0, s57
    s_nop 0
    buffer_load_dwordx4 v204, s[8:11], 0 offen lds
    s_add_u32 m0, s57, 1024
    s_nop 0
    buffer_load_dwordx4 v205, s[8:11], 0 offen lds
    s_add_u32 m0, s57, 2048
    s_mov_b32 exec_hi, 0
    buffer_load_dwordx4 v206, s[8:11], 0 offen lds
    s_add_u32 m0, s57, 2560
    s_mul_i32 s54, s7, 160
    s_mov_b32 exec_lo, 0x3ff
    buffer_load_dwordx4 v2, s[32:35], s54 offen lds
    s_mov_b64 exec, -1
    ds_read_b128 a[64:67], v5 offset:384
    ds_read_b128 a[68:71], v5 offset:1408
    s_add_u32 m0, s98, 80256
    s_add_u32 s42, s51, 307200
    buffer_load_dwordx4 v2, s[28:31], s42 offen sc1 lds
    v_mfma_f32_16x16x32_bf16 v[172:175], a[44:47], a[96:99], v[172:175]
    ds_read_b128 a[72:75], v5 offset:2432
    ds_read_b128 a[76:79], v5 offset:3456
    v_mfma_f32_16x16x32_bf16 v[176:179], a[44:47], a[100:103], v[176:179]
    ds_read_b128 a[80:83], v5 offset:4480
    buffer_load_dwordx4 v2, s[28:31], s42 offen offset:1024 sc1 lds
    s_waitcnt lgkmcnt(3)
    v_mfma_f32_16x16x32_bf16 v[160:163], a[48:51], a[64:67], v[160:163]
    ds_read_b128 a[84:87], v5 offset:5504
    v_mfma_f32_16x16x32_bf16 v[164:167], a[48:51], a[68:71], v[164:167]
    ds_read_b128 a[88:91], v5 offset:6528
    buffer_load_dwordx4 v2, s[28:31], s42 offen offset:2048 sc1 lds
    s_waitcnt lgkmcnt(3)
    v_mfma_f32_16x16x32_bf16 v[168:171], a[48:51], a[72:75], v[168:171]
    ds_read_b128 a[92:95], v5 offset:7552
    v_mfma_f32_16x16x32_bf16 v[172:175], a[48:51], a[76:79], v[172:175]
    ds_read_b128 a[96:99], v5 offset:8576
    buffer_load_dwordx4 v2, s[28:31], s42 offen offset:3072 sc1 lds
    s_waitcnt lgkmcnt(4)
    v_mfma_f32_16x16x32_bf16 v[176:179], a[48:51], a[80:83], v[176:179]
    ds_read_b128 a[100:103], v5 offset:9600
    s_waitcnt lgkmcnt(3)
    v_mfma_f32_16x16x32_bf16 v[160:163], a[52:55], a[84:87], v[160:163]
    ds_read_b128 a[64:67], v5 offset:10624
    s_add_u32 m0, s98, 84352
    s_add_u32 s42, s42, 4096
    buffer_load_dwordx4 v2, s[28:31], s42 offen sc1 lds
    v_mfma_f32_16x16x32_bf16 v[164:167], a[52:55], a[88:91], v[164:167]
    ds_read_b128 a[68:71], v5 offset:11648
    s_waitcnt lgkmcnt(3)
    v_mfma_f32_16x16x32_bf16 v[168:171], a[52:55], a[92:95], v[168:171]
    ds_read_b128 a[72:75], v5 offset:12672
    s_add_u32 s45, s44, 57344
    buffer_load_dwordx4 a[32:35], v2, s[28:31], s45 offen sc1
    v_mfma_f32_16x16x32_bf16 v[172:175], a[52:55], a[96:99], v[172:175]
    ds_read_b128 a[76:79], v5 offset:13696
    s_waitcnt lgkmcnt(4)
    v_mfma_f32_16x16x32_bf16 v[176:179], a[52:55], a[100:103], v[176:179]
    ds_read_b128 a[80:83], v5 offset:14720
    buffer_load_dwordx4 a[36:39], v2, s[28:31], s45 offen offset:1024 sc1
    s_waitcnt lgkmcnt(3)
    v_mfma_f32_16x16x32_bf16 v[160:163], a[56:59], a[64:67], v[160:163]
    ds_read_b128 a[84:87], v5 offset:15744
    v_mfma_f32_16x16x32_bf16 v[164:167], a[56:59], a[68:71], v[164:167]
    ds_read_b128 a[88:91], v5 offset:16768
    buffer_load_dwordx4 a[40:43], v2, s[28:31], s45 offen offset:2048 sc1
    s_waitcnt lgkmcnt(3)
    v_mfma_f32_16x16x32_bf16 v[168:171], a[56:59], a[72:75], v[168:171]
    ds_read_b128 a[92:95], v5 offset:17792
    v_mfma_f32_16x16x32_bf16 v[172:175], a[56:59], a[76:79], v[172:175]
    ds_read_b128 a[96:99], v5 offset:18816
    buffer_load_dwordx4 a[44:47], v2, s[28:31], s45 offen offset:3072 sc1
    s_waitcnt lgkmcnt(4)
    v_mfma_f32_16x16x32_bf16 v[176:179], a[56:59], a[80:83], v[176:179]
    ds_read_b128 a[100:103], v5 offset:19840
    s_waitcnt lgkmcnt(3)
    v_mfma_f32_16x16x32_bf16 v[160:163], a[60:63], a[84:87], v[160:163]
    v_mfma_f32_16x16x32_bf16 v[164:167], a[60:63], a[88:91], v[164:167]
    s_waitcnt lgkmcnt(1)
    v_mfma_f32_16x16x32_bf16 v[168:171], a[60:63], a[92:95], v[168:171]
    s_waitcnt vmcnt(17) lgkmcnt(0)
    s_barrier
    ds_read_b128 a[64:67], v4 offset:0
    ds_read_b128 a[68:71], v4 offset:1024
    s_add_u32 m0, s98, 100736
    s_add_u32 s42, s51, 327680
    buffer_load_dwordx4 v2, s[28:31], s42 offen sc1 lds
    v_mfma_f32_16x16x32_bf16 v[172:175], a[60:63], a[96:99], v[172:175]
    ds_read_b128 a[72:75], v4 offset:2048
    ds_read_b128 a[76:79], v4 offset:3072
    v_mfma_f32_16x16x32_bf16 v[176:179], a[60:63], a[100:103], v[176:179]
    ds_read_b128 a[80:83], v4 offset:4096
    buffer_load_dwordx4 v2, s[28:31], s42 offen offset:1024 sc1 lds
    s_waitcnt lgkmcnt(3)
    v_mfma_f32_16x16x32_bf16 v[180:183], a[0:3], a[64:67], 0
    ds_read_b128 a[84:87], v4 offset:5120
    v_mfma_f32_16x16x32_bf16 v[184:187], a[0:3], a[68:71], 0
    ds_read_b128 a[88:91], v4 offset:6144
    buffer_load_dwordx4 v2, s[28:31], s42 offen offset:2048 sc1 lds
    s_waitcnt lgkmcnt(3)
    v_mfma_f32_16x16x32_bf16 v[188:191], a[0:3], a[72:75], 0
    ds_read_b128 a[92:95], v4 offset:7168
    v_mfma_f32_16x16x32_bf16 v[192:195], a[0:3], a[76:79], 0
    ds_read_b128 a[96:99], v4 offset:8192
    buffer_load_dwordx4 v2, s[28:31], s42 offen offset:3072 sc1 lds
    s_waitcnt lgkmcnt(4)
    v_mfma_f32_16x16x32_bf16 v[196:199], a[0:3], a[80:83], 0
    ds_read_b128 a[100:103], v4 offset:9216
    s_waitcnt lgkmcnt(3)
    v_mfma_f32_16x16x32_bf16 v[180:183], a[4:7], a[84:87], v[180:183]
    ds_read_b128 a[64:67], v4 offset:10240
    s_add_u32 m0, s98, 104832
    s_add_u32 s42, s42, 4096
    buffer_load_dwordx4 v2, s[28:31], s42 offen sc1 lds
    v_mfma_f32_16x16x32_bf16 v[184:187], a[4:7], a[88:91], v[184:187]
    ds_read_b128 a[68:71], v4 offset:11264
    s_waitcnt lgkmcnt(3)
    v_mfma_f32_16x16x32_bf16 v[188:191], a[4:7], a[92:95], v[188:191]
    ds_read_b128 a[72:75], v4 offset:12288
    s_add_u32 s45, s44, 61440
    buffer_load_dwordx4 a[48:51], v2, s[28:31], s45 offen sc1
    v_mfma_f32_16x16x32_bf16 v[192:195], a[4:7], a[96:99], v[192:195]
    ds_read_b128 a[76:79], v4 offset:13312
    s_waitcnt lgkmcnt(4)
    v_mfma_f32_16x16x32_bf16 v[196:199], a[4:7], a[100:103], v[196:199]
    ds_read_b128 a[80:83], v4 offset:14336
    buffer_load_dwordx4 a[52:55], v2, s[28:31], s45 offen offset:1024 sc1
    s_waitcnt lgkmcnt(3)
    v_mfma_f32_16x16x32_bf16 v[180:183], a[8:11], a[64:67], v[180:183]
    ds_read_b128 a[84:87], v4 offset:15360
    v_mfma_f32_16x16x32_bf16 v[184:187], a[8:11], a[68:71], v[184:187]
    ds_read_b128 a[88:91], v4 offset:16384
    buffer_load_dwordx4 a[56:59], v2, s[28:31], s45 offen offset:2048 sc1
    s_waitcnt lgkmcnt(3)
    v_mfma_f32_16x16x32_bf16 v[188:191], a[8:11], a[72:75], v[188:191]
    ds_read_b128 a[92:95], v4 offset:17408
    v_mfma_f32_16x16x32_bf16 v[192:195], a[8:11], a[76:79], v[192:195]
    ds_read_b128 a[96:99], v4 offset:18432
    buffer_load_dwordx4 a[60:63], v2, s[28:31], s45 offen offset:3072 sc1
    s_waitcnt lgkmcnt(4)
    v_mfma_f32_16x16x32_bf16 v[196:199], a[8:11], a[80:83], v[196:199]
    ds_read_b128 a[100:103], v4 offset:19456
    s_waitcnt lgkmcnt(3)
    v_mfma_f32_16x16x32_bf16 v[180:183], a[12:15], a[84:87], v[180:183]
    v_mfma_f32_16x16x32_bf16 v[184:187], a[12:15], a[88:91], v[184:187]
    s_waitcnt lgkmcnt(1)
    v_mfma_f32_16x16x32_bf16 v[188:191], a[12:15], a[92:95], v[188:191]
    s_waitcnt vmcnt(22) lgkmcnt(0)
    s_barrier
    ds_read_b128 a[64:67], v3 offset:0
    ds_read_b128 a[68:71], v3 offset:1024
    s_add_u32 m0, s98, 49152
    s_add_u32 s42, s51, 348160
    buffer_load_dwordx4 v2, s[28:31], s42 offen sc1 lds
    v_mfma_f32_16x16x32_bf16 v[192:195], a[12:15], a[96:99], v[192:195]
    ds_read_b128 a[72:75], v3 offset:2048
    ds_read_b128 a[76:79], v3 offset:3072
    s_waitcnt vmcnt(19)
    ds_read_b64_tr_b16 v[80:81], v229 offset:0
    v_mfma_f32_16x16x32_bf16 v[196:199], a[12:15], a[100:103], v[196:199]
    ds_read_b128 a[80:83], v3 offset:4096
    buffer_load_dwordx4 v2, s[28:31], s42 offen offset:1024 sc1 lds
    s_waitcnt lgkmcnt(4)
    v_mfma_f32_16x16x32_bf16 v[180:183], a[16:19], a[64:67], v[180:183]
    ds_read_b128 a[84:87], v3 offset:5120
    ds_read_b64_tr_b16 v[82:83], v229 offset:32
    ds_read_b64_tr_b16 v[84:85], v229 offset:64
    ds_read_b64_tr_b16 v[86:87], v229 offset:96
    ds_read_b64_tr_b16 v[88:89], v229 offset:128
    v_mfma_f32_16x16x32_bf16 v[184:187], a[16:19], a[68:71], v[184:187]
    ds_read_b128 a[88:91], v3 offset:6144
    buffer_load_dwordx4 v2, s[28:31], s42 offen offset:2048 sc1 lds
    s_waitcnt lgkmcnt(8)
    v_mfma_f32_16x16x32_bf16 v[188:191], a[16:19], a[72:75], v[188:191]
    ds_read_b128 a[92:95], v3 offset:7168
    ds_read_u16_d16_hi v224, v230 offset:2560
    ds_read_u16_d16_hi v225, v230 offset:2592
    ds_read_u16_d16_hi v226, v230 offset:2624
    ds_read_u16_d16_hi v227, v230 offset:2656
    v_mfma_f32_16x16x32_bf16 v[192:195], a[16:19], a[76:79], v[192:195]
    ds_read_b128 a[96:99], v3 offset:8192
    buffer_load_dwordx4 v2, s[28:31], s42 offen offset:3072 sc1 lds
    s_waitcnt lgkmcnt(12)
    v_mfma_f32_16x16x32_bf16 v[196:199], a[16:19], a[80:83], v[196:199]
    ds_read_b128 a[100:103], v3 offset:9216
    ds_read_u16_d16_hi v228, v230 offset:2688
    s_waitcnt lgkmcnt(8)
    v_mfma_f32_16x16x32_bf16 v[180:183], a[20:23], a[84:87], v[180:183]
    ds_read_b128 a[64:67], v3 offset:10240
    s_add_u32 m0, s98, 53248
    s_add_u32 s42, s42, 4096
    buffer_load_dwordx4 v2, s[28:31], s42 offen sc1 lds
    v_mfma_f32_16x16x32_bf16 v[184:187], a[20:23], a[88:91], v[184:187]
    ds_read_b128 a[68:71], v3 offset:11264
    s_waitcnt lgkmcnt(4)
    v_mfma_f32_16x16x32_bf16 v[188:191], a[20:23], a[92:95], v[188:191]
    ds_read_b128 a[72:75], v3 offset:12288
    s_add_u32 s45, s44, 65536
    buffer_load_dwordx4 a[0:3], v2, s[28:31], s45 offen sc1
    v_mfma_f32_16x16x32_bf16 v[192:195], a[20:23], a[96:99], v[192:195]
    ds_read_b128 a[76:79], v3 offset:13312
    s_waitcnt lgkmcnt(5)
    v_mfma_f32_16x16x32_bf16 v[196:199], a[20:23], a[100:103], v[196:199]
    ds_read_b128 a[80:83], v3 offset:14336
    buffer_load_dwordx4 a[4:7], v2, s[28:31], s45 offen offset:1024 sc1
    s_waitcnt lgkmcnt(3)
    v_mfma_f32_16x16x32_bf16 v[180:183], a[24:27], a[64:67], v[180:183]
    ds_read_b128 a[84:87], v3 offset:15360
    v_mfma_f32_16x16x32_bf16 v[184:187], a[24:27], a[68:71], v[184:187]
    ds_read_b128 a[88:91], v3 offset:16384
    buffer_load_dwordx4 a[8:11], v2, s[28:31], s45 offen offset:2048 sc1
    s_waitcnt lgkmcnt(3)
    v_mfma_f32_16x16x32_bf16 v[188:191], a[24:27], a[72:75], v[188:191]
    ds_read_b128 a[92:95], v3 offset:17408
    v_mfma_f32_16x16x32_bf16 v[192:195], a[24:27], a[76:79], v[192:195]
    ds_read_b128 a[96:99], v3 offset:18432
    buffer_load_dwordx4 a[12:15], v2, s[28:31], s45 offen offset:3072 sc1
    s_waitcnt lgkmcnt(4)
    v_mfma_f32_16x16x32_bf16 v[196:199], a[24:27], a[80:83], v[196:199]
    ds_read_b128 a[100:103], v3 offset:19456
    s_waitcnt lgkmcnt(3)
    v_mfma_f32_16x16x32_bf16 v[180:183], a[28:31], a[84:87], v[180:183]
    v_mfma_f32_16x16x32_bf16 v[184:187], a[28:31], a[88:91], v[184:187]
    s_waitcnt lgkmcnt(1)
    v_mfma_f32_16x16x32_bf16 v[188:191], a[28:31], a[92:95], v[188:191]
    s_waitcnt vmcnt(18) lgkmcnt(0)
    s_barrier
    ds_read_b128 a[64:67], v3 offset:20480
    ds_read_b128 a[68:71], v3 offset:21504
    s_add_u32 m0, s98, 0
    s_add_u32 s42, s51, 368640
    buffer_load_dwordx4 v2, s[28:31], s42 offen sc1 lds
    v_mfma_f32_16x16x32_bf16 v[192:195], a[28:31], a[96:99], v[192:195]
    ds_read_b128 a[72:75], v3 offset:22528
    ds_read_b128 a[76:79], v3 offset:23552
    v_lshlrev_b32 v76, 2, v6
    v_add_u32 v76, 15138816, v76
    buffer_load_dwordx4 v[220:223], v76, s[28:31], 0 offen sc1
    v_mfma_f32_16x16x32_bf16 v[196:199], a[28:31], a[100:103], v[196:199]
    ds_read_b128 a[80:83], v3 offset:24576
    buffer_load_dwordx4 v2, s[28:31], s42 offen offset:1024 sc1 lds
    s_waitcnt lgkmcnt(3)
    v_mfma_f32_16x16x32_bf16 v[180:183], a[32:35], a[64:67], v[180:183]
    ds_read_b128 a[84:87], v3 offset:25600
    s_mov_b32 s32, s92
    s_and_b32 s33, s93, 0xffff
    s_mov_b32 s34, 5242880
    s_mov_b32 s35, 0x20000
    v_mfma_f32_16x16x32_bf16 v[184:187], a[32:35], a[68:71], v[184:187]
    ds_read_b128 a[88:91], v3 offset:26624
    buffer_load_dwordx4 v2, s[28:31], s42 offen offset:2048 sc1 lds
    s_waitcnt lgkmcnt(3)
    v_mfma_f32_16x16x32_bf16 v[188:191], a[32:35], a[72:75], v[188:191]
    ds_read_b128 a[92:95], v3 offset:27648
    s_movk_i32 s53, 2560
    v_mul_lo_u32 v72, v6, s53
    v_lshl_add_u32 v72, v7, 2, v72
    v_add_u32 v73, 5120, v72
    v_mfma_f32_16x16x32_bf16 v[192:195], a[32:35], a[76:79], v[192:195]
    ds_read_b128 a[96:99], v3 offset:28672
    buffer_load_dwordx4 v2, s[28:31], s42 offen offset:3072 sc1 lds
    s_waitcnt lgkmcnt(4)
    v_mfma_f32_16x16x32_bf16 v[196:199], a[32:35], a[80:83], v[196:199]
    ds_read_b128 a[100:103], v3 offset:29696
    s_waitcnt lgkmcnt(3)
    v_mfma_f32_16x16x32_bf16 v[180:183], a[36:39], a[84:87], v[180:183]
    ds_read_b128 a[64:67], v3 offset:30720
    s_add_u32 m0, s98, 4096
    s_add_u32 s42, s42, 4096
    buffer_load_dwordx4 v2, s[28:31], s42 offen sc1 lds
    v_mfma_f32_16x16x32_bf16 v[184:187], a[36:39], a[88:91], v[184:187]
    ds_read_b128 a[68:71], v3 offset:31744
    s_waitcnt lgkmcnt(3)
    v_mfma_f32_16x16x32_bf16 v[188:191], a[36:39], a[92:95], v[188:191]
    ds_read_b128 a[72:75], v3 offset:32768
    s_add_u32 s45, s44, 69632
    buffer_load_dwordx4 a[16:19], v2, s[28:31], s45 offen sc1
    v_mfma_f32_16x16x32_bf16 v[192:195], a[36:39], a[96:99], v[192:195]
    ds_read_b128 a[76:79], v3 offset:33792
    s_waitcnt lgkmcnt(4)
    v_mfma_f32_16x16x32_bf16 v[196:199], a[36:39], a[100:103], v[196:199]
    ds_read_b128 a[80:83], v3 offset:34816
    buffer_load_dwordx4 a[20:23], v2, s[28:31], s45 offen offset:1024 sc1
    s_waitcnt lgkmcnt(3)
    v_mfma_f32_16x16x32_bf16 v[180:183], a[40:43], a[64:67], v[180:183]
    ds_read_b128 a[84:87], v3 offset:35840
    v_mfma_f32_16x16x32_bf16 v[184:187], a[40:43], a[68:71], v[184:187]
    ds_read_b128 a[88:91], v3 offset:36864
    buffer_load_dwordx4 a[24:27], v2, s[28:31], s45 offen offset:2048 sc1
    s_waitcnt lgkmcnt(3)
    v_mfma_f32_16x16x32_bf16 v[188:191], a[40:43], a[72:75], v[188:191]
    ds_read_b128 a[92:95], v3 offset:37888
    v_mfma_f32_16x16x32_bf16 v[192:195], a[40:43], a[76:79], v[192:195]
    ds_read_b128 a[96:99], v3 offset:38912
    buffer_load_dwordx4 a[28:31], v2, s[28:31], s45 offen offset:3072 sc1
    s_waitcnt lgkmcnt(4)
    v_mfma_f32_16x16x32_bf16 v[196:199], a[40:43], a[80:83], v[196:199]
    ds_read_b128 a[100:103], v3 offset:39936
    s_waitcnt lgkmcnt(3)
    v_mfma_f32_16x16x32_bf16 v[180:183], a[44:47], a[84:87], v[180:183]
    v_mfma_f32_16x16x32_bf16 v[184:187], a[44:47], a[88:91], v[184:187]
    s_waitcnt lgkmcnt(1)
    v_mfma_f32_16x16x32_bf16 v[188:191], a[44:47], a[92:95], v[188:191]
    s_waitcnt vmcnt(19) lgkmcnt(0)
    s_barrier
    ds_read_b128 a[64:67], v4 offset:31104
    ds_read_b128 a[68:71], v4 offset:32128
    s_add_u32 m0, s98, 20480
    s_add_u32 s42, s51, 389120
    buffer_load_dwordx4 v2, s[28:31], s42 offen sc1 lds
    v_mfma_f32_16x16x32_bf16 v[192:195], a[44:47], a[96:99], v[192:195]
    ds_read_b128 a[72:75], v4 offset:33152
    ds_read_b128 a[76:79], v4 offset:34176
    v_mfma_f32_16x16x32_bf16 v[196:199], a[44:47], a[100:103], v[196:199]
    ds_read_b128 a[80:83], v4 offset:35200
    buffer_load_dwordx4 v2, s[28:31], s42 offen offset:1024 sc1 lds
    s_waitcnt lgkmcnt(3)
    v_mfma_f32_16x16x32_bf16 v[180:183], a[48:51], a[64:67], v[180:183]
    ds_read_b128 a[84:87], v4 offset:36224
    v_mfma_f32_16x16x32_bf16 v[184:187], a[48:51], a[68:71], v[184:187]
    ds_read_b128 a[88:91], v4 offset:37248
    buffer_load_dwordx4 v2, s[28:31], s42 offen offset:2048 sc1 lds
    s_waitcnt lgkmcnt(3)
    v_mfma_f32_16x16x32_bf16 v[188:191], a[48:51], a[72:75], v[188:191]
    ds_read_b128 a[92:95], v4 offset:38272
    v_mfma_f32_16x16x32_bf16 v[192:195], a[48:51], a[76:79], v[192:195]
    ds_read_b128 a[96:99], v4 offset:39296
    buffer_load_dwordx4 v2, s[28:31], s42 offen offset:3072 sc1 lds
    s_waitcnt lgkmcnt(4)
    v_mfma_f32_16x16x32_bf16 v[196:199], a[48:51], a[80:83], v[196:199]
    ds_read_b128 a[100:103], v4 offset:40320
    s_waitcnt lgkmcnt(3)
    v_mfma_f32_16x16x32_bf16 v[180:183], a[52:55], a[84:87], v[180:183]
    ds_read_b128 a[64:67], v4 offset:41344
    s_add_u32 m0, s98, 24576
    s_add_u32 s42, s42, 4096
    buffer_load_dwordx4 v2, s[28:31], s42 offen sc1 lds
    v_mfma_f32_16x16x32_bf16 v[184:187], a[52:55], a[88:91], v[184:187]
    ds_read_b128 a[68:71], v4 offset:42368
    s_waitcnt lgkmcnt(3)
    v_mfma_f32_16x16x32_bf16 v[188:191], a[52:55], a[92:95], v[188:191]
    ds_read_b128 a[72:75], v4 offset:43392
    s_add_u32 s45, s44, 73728
    buffer_load_dwordx4 a[32:35], v2, s[28:31], s45 offen sc1
    v_mfma_f32_16x16x32_bf16 v[192:195], a[52:55], a[96:99], v[192:195]
    ds_read_b128 a[76:79], v4 offset:44416
    s_waitcnt lgkmcnt(4)
    v_mfma_f32_16x16x32_bf16 v[196:199], a[52:55], a[100:103], v[196:199]
    ds_read_b128 a[80:83], v4 offset:45440
    buffer_load_dwordx4 a[36:39], v2, s[28:31], s45 offen offset:1024 sc1
    s_waitcnt lgkmcnt(3)
    v_mfma_f32_16x16x32_bf16 v[180:183], a[56:59], a[64:67], v[180:183]
    ds_read_b128 a[84:87], v4 offset:46464
    v_mfma_f32_16x16x32_bf16 v[184:187], a[56:59], a[68:71], v[184:187]
    ds_read_b128 a[88:91], v4 offset:47488
    buffer_load_dwordx4 a[40:43], v2, s[28:31], s45 offen offset:2048 sc1
    s_waitcnt lgkmcnt(3)
    v_mfma_f32_16x16x32_bf16 v[188:191], a[56:59], a[72:75], v[188:191]
    ds_read_b128 a[92:95], v4 offset:48512
    v_mfma_f32_16x16x32_bf16 v[192:195], a[56:59], a[76:79], v[192:195]
    ds_read_b128 a[96:99], v4 offset:49536
    buffer_load_dwordx4 a[44:47], v2, s[28:31], s45 offen offset:3072 sc1
    s_waitcnt lgkmcnt(4)
    v_mfma_f32_16x16x32_bf16 v[196:199], a[56:59], a[80:83], v[196:199]
    ds_read_b128 a[100:103], v4 offset:50560
    s_waitcnt lgkmcnt(3)
    v_mfma_f32_16x16x32_bf16 v[180:183], a[60:63], a[84:87], v[180:183]
    v_mfma_f32_16x16x32_bf16 v[184:187], a[60:63], a[88:91], v[184:187]
    s_waitcnt lgkmcnt(1)
    v_mfma_f32_16x16x32_bf16 v[188:191], a[60:63], a[92:95], v[188:191]
    s_waitcnt vmcnt(19) lgkmcnt(0)
    s_barrier
    ds_read_b128 a[64:67], v5 offset:384
    ds_read_b128 a[68:71], v5 offset:1408
    s_add_u32 m0, s98, 80256
    s_add_u32 s42, s51, 409600
    buffer_load_dwordx4 v2, s[28:31], s42 offen sc1 lds
    v_mfma_f32_16x16x32_bf16 v[192:195], a[60:63], a[96:99], v[192:195]
    ds_read_b128 a[72:75], v5 offset:2432
    ds_read_b128 a[76:79], v5 offset:3456
    s_waitcnt vmcnt(18)
    v_sub_f32 v64, 1.0, v220
    v_add_f32_e64 v68, v220, v220
    v_mfma_f32_16x16x32_bf16 v[196:199], a[60:63], a[100:103], v[196:199]
    ds_read_b128 a[80:83], v5 offset:4480
    buffer_load_dwordx4 v2, s[28:31], s42 offen offset:1024 sc1 lds
    s_waitcnt lgkmcnt(3)
    v_mfma_f32_16x16x32_bf16 v[180:183], a[0:3], a[64:67], v[180:183]
    ds_read_b128 a[84:87], v5 offset:5504
    v_sub_f32 v65, 1.0, v221
    v_add_f32 v69, v221, v221
    v_sub_f32 v66, 1.0, v222
    v_add_f32_e64 v70, v222, v222
    v_mfma_f32_16x16x32_bf16 v[184:187], a[0:3], a[68:71], v[184:187]
    ds_read_b128 a[88:91], v5 offset:6528
    buffer_load_dwordx4 v2, s[28:31], s42 offen offset:2048 sc1 lds
    s_waitcnt lgkmcnt(3)
    v_mfma_f32_16x16x32_bf16 v[188:191], a[0:3], a[72:75], v[188:191]
    ds_read_b128 a[92:95], v5 offset:7552
    v_sub_f32 v67, 1.0, v223
    v_add_f32_e64 v71, v223, v223
    v_and_b32 v224, 0xffff0000, v224
    v_and_b32 v225, 0xffff0000, v225
    v_and_b32 v226, 0xffff0000, v226
    v_and_b32 v227, 0xffff0000, v227
    v_and_b32 v228, 0xffff0000, v228
    v_mfma_f32_16x16x32_bf16 v[192:195], a[0:3], a[76:79], v[192:195]
    ds_read_b128 a[96:99], v5 offset:8576
    buffer_load_dwordx4 v2, s[28:31], s42 offen offset:3072 sc1 lds
    s_waitcnt lgkmcnt(4)
    v_mfma_f32_16x16x32_bf16 v[196:199], a[0:3], a[80:83], v[196:199]
    ds_read_b128 a[100:103], v5 offset:9600
    v_lshlrev_b32 v200, 16, v80
    v_mul_f32 v200, v200, v224
    v_mul_f32 v160, v64, v160
    v_fma_f32 v200, v220, v200, v160
    s_waitcnt lgkmcnt(3)
    v_mfma_f32_16x16x32_bf16 v[180:183], a[4:7], a[84:87], v[180:183]
    ds_read_b128 a[64:67], v5 offset:10624
    s_add_u32 m0, s98, 84352
    s_add_u32 s42, s42, 4096
    buffer_load_dwordx4 v2, s[28:31], s42 offen sc1 lds
    v_mfma_f32_16x16x32_bf16 v[184:187], a[4:7], a[88:91], v[184:187]
    ds_read_b128 a[68:71], v5 offset:11648
    v_and_b32 v205, 0xffff0000, v80
    v_mul_f32 v205, v205, v224
    v_mul_f32_e64 v161, v65, v161
    v_fma_f32 v205, v221, v205, v161
    s_waitcnt lgkmcnt(3)
    v_mfma_f32_16x16x32_bf16 v[188:191], a[4:7], a[92:95], v[188:191]
    ds_read_b128 a[72:75], v5 offset:12672
    s_add_u32 s45, s44, 77824
    buffer_load_dwordx4 a[48:51], v2, s[28:31], s45 offen sc1
    v_mfma_f32_16x16x32_bf16 v[192:195], a[4:7], a[96:99], v[192:195]
    ds_read_b128 a[76:79], v5 offset:13696
    v_lshlrev_b32 v210, 16, v81
    v_mul_f32 v210, v210, v224
    v_mul_f32 v162, v66, v162
    v_fma_f32 v210, v222, v210, v162
    s_waitcnt lgkmcnt(4)
    v_mfma_f32_16x16x32_bf16 v[196:199], a[4:7], a[100:103], v[196:199]
    ds_read_b128 a[80:83], v5 offset:14720
    buffer_load_dwordx4 a[52:55], v2, s[28:31], s45 offen offset:1024 sc1
    s_waitcnt lgkmcnt(3)
    v_mfma_f32_16x16x32_bf16 v[180:183], a[8:11], a[64:67], v[180:183]
    ds_read_b128 a[84:87], v5 offset:15744
    v_and_b32 v215, 0xffff0000, v81
    v_mul_f32 v215, v215, v224
    v_mul_f32 v163, v67, v163
    v_fma_f32 v215, v223, v215, v163
    v_mfma_f32_16x16x32_bf16 v[184:187], a[8:11], a[68:71], v[184:187]
    ds_read_b128 a[88:91], v5 offset:16768
    buffer_load_dwordx4 a[56:59], v2, s[28:31], s45 offen offset:2048 sc1
    s_waitcnt lgkmcnt(3)
    v_mfma_f32_16x16x32_bf16 v[188:191], a[8:11], a[72:75], v[188:191]
    ds_read_b128 a[92:95], v5 offset:17792
    v_lshlrev_b32 v201, 16, v82
    v_mul_f32 v201, v201, v225
    v_mul_f32 v164, v64, v164
    v_fma_f32 v201, v220, v201, v164
    v_mfma_f32_16x16x32_bf16 v[192:195], a[8:11], a[76:79], v[192:195]
    ds_read_b128 a[96:99], v5 offset:18816
    buffer_load_dwordx4 a[60:63], v2, s[28:31], s45 offen offset:3072 sc1
    s_waitcnt lgkmcnt(4)
    v_mfma_f32_16x16x32_bf16 v[196:199], a[8:11], a[80:83], v[196:199]
    ds_read_b128 a[100:103], v5 offset:19840
    v_and_b32 v206, 0xffff0000, v82
    v_mul_f32 v206, v206, v225
    v_mul_f32_e64 v165, v65, v165
    v_fma_f32 v206, v221, v206, v165
    s_waitcnt lgkmcnt(3)
    v_mfma_f32_16x16x32_bf16 v[180:183], a[12:15], a[84:87], v[180:183]
    v_mfma_f32_16x16x32_bf16 v[184:187], a[12:15], a[88:91], v[184:187]
    s_waitcnt lgkmcnt(1)
    v_mfma_f32_16x16x32_bf16 v[188:191], a[12:15], a[92:95], v[188:191]
    s_waitcnt vmcnt(18) lgkmcnt(0)
    s_barrier
    ds_read_b128 a[64:67], v4 offset:0
    ds_read_b128 a[68:71], v4 offset:1024
    s_add_u32 m0, s98, 100736
    s_add_u32 s42, s51, 430080
    buffer_load_dwordx4 v2, s[28:31], s42 offen sc1 lds
    v_mfma_f32_16x16x32_bf16 v[192:195], a[12:15], a[96:99], v[192:195]
    ds_read_b128 a[72:75], v4 offset:2048
    ds_read_b128 a[76:79], v4 offset:3072
    v_lshlrev_b32 v211, 16, v83
    v_mul_f32 v211, v211, v225
    v_mfma_f32_16x16x32_bf16 v[196:199], a[12:15], a[100:103], v[196:199]
    ds_read_b128 a[80:83], v4 offset:4096
    buffer_load_dwordx4 v2, s[28:31], s42 offen offset:1024 sc1 lds
    s_waitcnt lgkmcnt(3)
    v_mfma_f32_16x16x32_bf16 v[180:183], a[16:19], a[64:67], v[180:183]
    ds_read_b128 a[84:87], v4 offset:5120
    v_mul_f32 v166, v66, v166
    v_fma_f32 v211, v222, v211, v166
    v_and_b32 v216, 0xffff0000, v83
    v_mul_f32_e64 v216, v216, v225
    v_mfma_f32_16x16x32_bf16 v[184:187], a[16:19], a[68:71], v[184:187]
    ds_read_b128 a[88:91], v4 offset:6144
    buffer_load_dwordx4 v2, s[28:31], s42 offen offset:2048 sc1 lds
    s_waitcnt lgkmcnt(3)
    v_mfma_f32_16x16x32_bf16 v[188:191], a[16:19], a[72:75], v[188:191]
    ds_read_b128 a[92:95], v4 offset:7168
    v_mul_f32 v167, v67, v167
    v_fma_f32 v216, v223, v216, v167
    v_lshlrev_b32 v202, 16, v84
    v_mul_f32 v202, v202, v226
    v_mfma_f32_16x16x32_bf16 v[192:195], a[16:19], a[76:79], v[192:195]
    ds_read_b128 a[96:99], v4 offset:8192
    buffer_load_dwordx4 v2, s[28:31], s42 offen offset:3072 sc1 lds
    s_waitcnt lgkmcnt(4)
    v_mfma_f32_16x16x32_bf16 v[196:199], a[16:19], a[80:83], v[196:199]
    ds_read_b128 a[100:103], v4 offset:9216
    v_mul_f32 v168, v64, v168
    v_fma_f32 v202, v220, v202, v168
    v_and_b32 v207, 0xffff0000, v84
    v_mul_f32 v207, v207, v226
    s_waitcnt lgkmcnt(3)
    v_mfma_f32_16x16x32_bf16 v[180:183], a[20:23], a[84:87], v[180:183]
    ds_read_b128 a[64:67], v4 offset:10240
    s_add_u32 m0, s98, 104832
    s_add_u32 s42, s42, 4096
    buffer_load_dwordx4 v2, s[28:31], s42 offen sc1 lds
    v_mfma_f32_16x16x32_bf16 v[184:187], a[20:23], a[88:91], v[184:187]
    ds_read_b128 a[68:71], v4 offset:11264
    v_mul_f32_e64 v169, v65, v169
    v_fma_f32 v207, v221, v207, v169
    v_lshlrev_b32 v212, 16, v85
    v_mul_f32 v212, v212, v226
    s_waitcnt lgkmcnt(3)
    v_mfma_f32_16x16x32_bf16 v[188:191], a[20:23], a[92:95], v[188:191]
    ds_read_b128 a[72:75], v4 offset:12288
    s_add_u32 s45, s44, 81920
    buffer_load_dwordx4 a[0:3], v2, s[28:31], s45 offen sc1
    v_mfma_f32_16x16x32_bf16 v[192:195], a[20:23], a[96:99], v[192:195]
    ds_read_b128 a[76:79], v4 offset:13312
    v_mul_f32 v170, v66, v170
    v_fma_f32 v212, v222, v212, v170
    v_and_b32 v217, 0xffff0000, v85
    v_mul_f32 v217, v217, v226
    s_waitcnt lgkmcnt(4)
    v_mfma_f32_16x16x32_bf16 v[196:199], a[20:23], a[100:103], v[196:199]
    ds_read_b128 a[80:83], v4 offset:14336
    buffer_load_dwordx4 a[4:7], v2, s[28:31], s45 offen offset:1024 sc1
    s_waitcnt lgkmcnt(3)
    v_mfma_f32_16x16x32_bf16 v[180:183], a[24:27], a[64:67], v[180:183]
    ds_read_b128 a[84:87], v4 offset:15360
    v_mul_f32 v171, v67, v171
    v_fma_f32 v217, v223, v217, v171
    v_lshlrev_b32 v203, 16, v86
    v_mul_f32 v203, v203, v227
    v_mfma_f32_16x16x32_bf16 v[184:187], a[24:27], a[68:71], v[184:187]
    ds_read_b128 a[88:91], v4 offset:16384
    buffer_load_dwordx4 a[8:11], v2, s[28:31], s45 offen offset:2048 sc1
    s_waitcnt lgkmcnt(3)
    v_mfma_f32_16x16x32_bf16 v[188:191], a[24:27], a[72:75], v[188:191]
    ds_read_b128 a[92:95], v4 offset:17408
    v_mul_f32 v172, v64, v172
    v_fma_f32 v203, v220, v203, v172
    v_and_b32 v208, 0xffff0000, v86
    v_mul_f32_e64 v208, v208, v227
    v_mfma_f32_16x16x32_bf16 v[192:195], a[24:27], a[76:79], v[192:195]
    ds_read_b128 a[96:99], v4 offset:18432
    buffer_load_dwordx4 a[12:15], v2, s[28:31], s45 offen offset:3072 sc1
    s_waitcnt lgkmcnt(4)
    v_mfma_f32_16x16x32_bf16 v[196:199], a[24:27], a[80:83], v[196:199]
    ds_read_b128 a[100:103], v4 offset:19456
    v_mul_f32 v173, v65, v173
    v_fma_f32 v208, v221, v208, v173
    v_lshlrev_b32 v213, 16, v87
    v_mul_f32 v213, v213, v227
    s_waitcnt lgkmcnt(3)
    v_mfma_f32_16x16x32_bf16 v[180:183], a[28:31], a[84:87], v[180:183]
    v_mfma_f32_16x16x32_bf16 v[184:187], a[28:31], a[88:91], v[184:187]
    s_waitcnt lgkmcnt(1)
    v_mfma_f32_16x16x32_bf16 v[188:191], a[28:31], a[92:95], v[188:191]
    s_waitcnt vmcnt(18) lgkmcnt(0)
    s_barrier
    ds_read_b128 a[64:67], v3 offset:0
    ds_read_b128 a[68:71], v3 offset:1024
    s_add_u32 s45, s44, 86016
    buffer_load_dwordx4 a[16:19], v2, s[28:31], s45 offen sc1
    v_mfma_f32_16x16x32_bf16 v[192:195], a[28:31], a[96:99], v[192:195]
    ds_read_b128 a[72:75], v3 offset:2048
    ds_read_b128 a[76:79], v3 offset:3072
    v_mul_f32_e64 v174, v66, v174
    v_fma_f32 v213, v222, v213, v174
    v_mfma_f32_16x16x32_bf16 v[196:199], a[28:31], a[100:103], v[196:199]
    ds_read_b128 a[80:83], v3 offset:4096
    v_and_b32 v218, 0xffff0000, v87
    v_mul_f32 v218, v218, v227
    v_mul_f32 v175, v67, v175
    v_fma_f32 v218, v223, v218, v175
    s_waitcnt lgkmcnt(3)
    v_mfma_f32_16x16x32_bf16 v[180:183], a[32:35], a[64:67], v[180:183]
    ds_read_b128 a[84:87], v3 offset:5120
    v_lshlrev_b32 v204, 16, v88
    v_mul_f32 v204, v204, v228
    v_mul_f32 v176, v64, v176
    v_fma_f32 v204, v220, v204, v176
    v_mfma_f32_16x16x32_bf16 v[184:187], a[32:35], a[68:71], v[184:187]
    ds_read_b128 a[88:91], v3 offset:6144
    buffer_load_dwordx4 a[20:23], v2, s[28:31], s45 offen offset:1024 sc1
    s_waitcnt lgkmcnt(3)
    v_mfma_f32_16x16x32_bf16 v[188:191], a[32:35], a[72:75], v[188:191]
    ds_read_b128 a[92:95], v3 offset:7168
    v_and_b32 v209, 0xffff0000, v88
    v_mul_f32 v209, v209, v228
    v_mul_f32_e64 v177, v65, v177
    v_fma_f32 v209, v221, v209, v177
    v_mfma_f32_16x16x32_bf16 v[192:195], a[32:35], a[76:79], v[192:195]
    ds_read_b128 a[96:99], v3 offset:8192
    v_lshlrev_b32 v214, 16, v89
    v_mul_f32 v214, v214, v228
    v_mul_f32_e64 v178, v66, v178
    v_fma_f32 v214, v222, v214, v178
    s_waitcnt lgkmcnt(4)
    v_mfma_f32_16x16x32_bf16 v[196:199], a[32:35], a[80:83], v[196:199]
    ds_read_b128 a[100:103], v3 offset:9216
    v_and_b32 v219, 0xffff0000, v89
    v_mul_f32 v219, v219, v228
    v_mul_f32_e64 v179, v67, v179
    v_fma_f32 v219, v223, v219, v179
    s_waitcnt lgkmcnt(3)
    v_mfma_f32_16x16x32_bf16 v[180:183], a[36:39], a[84:87], v[180:183]
    ds_read_b128 a[64:67], v3 offset:10240
    v_mfma_f32_16x16x32_bf16 v[184:187], a[36:39], a[88:91], v[184:187]
    ds_read_b128 a[68:71], v3 offset:11264
    buffer_load_dwordx4 a[24:27], v2, s[28:31], s45 offen offset:2048 sc1
    s_waitcnt lgkmcnt(3)
    v_mfma_f32_16x16x32_bf16 v[188:191], a[36:39], a[92:95], v[188:191]
    ds_read_b128 a[72:75], v3 offset:12288
    v_mfma_f32_16x16x32_bf16 v[192:195], a[36:39], a[96:99], v[192:195]
    ds_read_b128 a[76:79], v3 offset:13312
    s_waitcnt lgkmcnt(4)
    v_mfma_f32_16x16x32_bf16 v[196:199], a[36:39], a[100:103], v[196:199]
    ds_read_b128 a[80:83], v3 offset:14336
    s_waitcnt lgkmcnt(3)
    v_mfma_f32_16x16x32_bf16 v[180:183], a[40:43], a[64:67], v[180:183]
    ds_read_b128 a[84:87], v3 offset:15360
    buffer_load_dwordx4 a[28:31], v2, s[28:31], s45 offen offset:3072 sc1
    v_mfma_f32_16x16x32_bf16 v[184:187], a[40:43], a[68:71], v[184:187]
    ds_read_b128 a[88:91], v3 offset:16384
    s_waitcnt lgkmcnt(3)
    v_mfma_f32_16x16x32_bf16 v[188:191], a[40:43], a[72:75], v[188:191]
    ds_read_b128 a[92:95], v3 offset:17408
    v_mfma_f32_16x16x32_bf16 v[192:195], a[40:43], a[76:79], v[192:195]
    ds_read_b128 a[96:99], v3 offset:18432
    s_waitcnt lgkmcnt(4)
    v_mfma_f32_16x16x32_bf16 v[196:199], a[40:43], a[80:83], v[196:199]
    ds_read_b128 a[100:103], v3 offset:19456
    s_waitcnt lgkmcnt(3)
    v_mfma_f32_16x16x32_bf16 v[180:183], a[44:47], a[84:87], v[180:183]
    v_mfma_f32_16x16x32_bf16 v[184:187], a[44:47], a[88:91], v[184:187]
    s_waitcnt lgkmcnt(1)
    v_mfma_f32_16x16x32_bf16 v[188:191], a[44:47], a[92:95], v[188:191]
    s_waitcnt vmcnt(13) lgkmcnt(0)
    s_barrier
    ds_read_b128 a[64:67], v3 offset:20480
    ds_read_b128 a[68:71], v3 offset:21504
    v_mfma_f32_16x16x32_bf16 v[192:195], a[44:47], a[96:99], v[192:195]
    ds_read_b128 a[72:75], v3 offset:22528
    ds_read_b128 a[76:79], v3 offset:23552
    v_mfma_f32_16x16x32_bf16 v[196:199], a[44:47], a[100:103], v[196:199]
    ds_read_b128 a[80:83], v3 offset:24576
    s_waitcnt lgkmcnt(3)
    v_mfma_f32_16x16x32_bf16 v[180:183], a[48:51], a[64:67], v[180:183]
    ds_read_b128 a[84:87], v3 offset:25600
    v_mfma_f32_16x16x32_bf16 v[184:187], a[48:51], a[68:71], v[184:187]
    ds_read_b128 a[88:91], v3 offset:26624
    s_waitcnt lgkmcnt(3)
    v_mfma_f32_16x16x32_bf16 v[188:191], a[48:51], a[72:75], v[188:191]
    ds_read_b128 a[92:95], v3 offset:27648
    v_mfma_f32_16x16x32_bf16 v[192:195], a[48:51], a[76:79], v[192:195]
    ds_read_b128 a[96:99], v3 offset:28672
    s_waitcnt lgkmcnt(4)
    v_mfma_f32_16x16x32_bf16 v[196:199], a[48:51], a[80:83], v[196:199]
    ds_read_b128 a[100:103], v3 offset:29696
    s_waitcnt lgkmcnt(3)
    v_mfma_f32_16x16x32_bf16 v[180:183], a[52:55], a[84:87], v[180:183]
    ds_read_b128 a[64:67], v3 offset:30720
    v_mfma_f32_16x16x32_bf16 v[184:187], a[52:55], a[88:91], v[184:187]
    ds_read_b128 a[68:71], v3 offset:31744
    s_waitcnt lgkmcnt(3)
    v_mfma_f32_16x16x32_bf16 v[188:191], a[52:55], a[92:95], v[188:191]
    ds_read_b128 a[72:75], v3 offset:32768
    v_mfma_f32_16x16x32_bf16 v[192:195], a[52:55], a[96:99], v[192:195]
    ds_read_b128 a[76:79], v3 offset:33792
    s_waitcnt lgkmcnt(4)
    v_mfma_f32_16x16x32_bf16 v[196:199], a[52:55], a[100:103], v[196:199]
    ds_read_b128 a[80:83], v3 offset:34816
    s_waitcnt lgkmcnt(3)
    v_mfma_f32_16x16x32_bf16 v[180:183], a[56:59], a[64:67], v[180:183]
    ds_read_b128 a[84:87], v3 offset:35840
    v_mfma_f32_16x16x32_bf16 v[184:187], a[56:59], a[68:71], v[184:187]
    ds_read_b128 a[88:91], v3 offset:36864
    s_waitcnt lgkmcnt(3)
    v_mfma_f32_16x16x32_bf16 v[188:191], a[56:59], a[72:75], v[188:191]
    ds_read_b128 a[92:95], v3 offset:37888
    v_mfma_f32_16x16x32_bf16 v[192:195], a[56:59], a[76:79], v[192:195]
    ds_read_b128 a[96:99], v3 offset:38912
    s_waitcnt lgkmcnt(4)
    v_mfma_f32_16x16x32_bf16 v[196:199], a[56:59], a[80:83], v[196:199]
    ds_read_b128 a[100:103], v3 offset:39936
    s_waitcnt lgkmcnt(3)
    v_mfma_f32_16x16x32_bf16 v[180:183], a[60:63], a[84:87], v[180:183]
    v_mfma_f32_16x16x32_bf16 v[184:187], a[60:63], a[88:91], v[184:187]
    s_waitcnt lgkmcnt(1)
    v_mfma_f32_16x16x32_bf16 v[188:191], a[60:63], a[92:95], v[188:191]
    s_waitcnt vmcnt(4) lgkmcnt(0)
    s_barrier
    ds_read_b128 a[64:67], v4 offset:31104
    ds_read_b128 a[68:71], v4 offset:32128
    v_mfma_f32_16x16x32_bf16 v[192:195], a[60:63], a[96:99], v[192:195]
    ds_read_b128 a[72:75], v4 offset:33152
    ds_read_b128 a[76:79], v4 offset:34176
    v_mfma_f32_16x16x32_bf16 v[196:199], a[60:63], a[100:103], v[196:199]
    ds_read_b128 a[80:83], v4 offset:35200
    s_waitcnt lgkmcnt(3)
    v_mfma_f32_16x16x32_bf16 v[180:183], a[0:3], a[64:67], v[180:183]
    ds_read_b128 a[84:87], v4 offset:36224
    v_mfma_f32_16x16x32_bf16 v[184:187], a[0:3], a[68:71], v[184:187]
    ds_read_b128 a[88:91], v4 offset:37248
    s_waitcnt lgkmcnt(3)
    v_mfma_f32_16x16x32_bf16 v[188:191], a[0:3], a[72:75], v[188:191]
    ds_read_b128 a[92:95], v4 offset:38272
    v_mfma_f32_16x16x32_bf16 v[192:195], a[0:3], a[76:79], v[192:195]
    ds_read_b128 a[96:99], v4 offset:39296
    s_waitcnt lgkmcnt(4)
    v_mfma_f32_16x16x32_bf16 v[196:199], a[0:3], a[80:83], v[196:199]
    ds_read_b128 a[100:103], v4 offset:40320
    s_waitcnt lgkmcnt(3)
    v_mfma_f32_16x16x32_bf16 v[180:183], a[4:7], a[84:87], v[180:183]
    ds_read_b128 a[64:67], v4 offset:41344
    v_mfma_f32_16x16x32_bf16 v[184:187], a[4:7], a[88:91], v[184:187]
    ds_read_b128 a[68:71], v4 offset:42368
    s_waitcnt lgkmcnt(3)
    v_mfma_f32_16x16x32_bf16 v[188:191], a[4:7], a[92:95], v[188:191]
    ds_read_b128 a[72:75], v4 offset:43392
    v_mfma_f32_16x16x32_bf16 v[192:195], a[4:7], a[96:99], v[192:195]
    ds_read_b128 a[76:79], v4 offset:44416
    s_waitcnt lgkmcnt(4)
    v_mfma_f32_16x16x32_bf16 v[196:199], a[4:7], a[100:103], v[196:199]
    ds_read_b128 a[80:83], v4 offset:45440
    s_waitcnt lgkmcnt(3)
    v_mfma_f32_16x16x32_bf16 v[180:183], a[8:11], a[64:67], v[180:183]
    ds_read_b128 a[84:87], v4 offset:46464
    v_mfma_f32_16x16x32_bf16 v[184:187], a[8:11], a[68:71], v[184:187]
    ds_read_b128 a[88:91], v4 offset:47488
    s_waitcnt lgkmcnt(3)
    v_mfma_f32_16x16x32_bf16 v[188:191], a[8:11], a[72:75], v[188:191]
    ds_read_b128 a[92:95], v4 offset:48512
    v_mfma_f32_16x16x32_bf16 v[192:195], a[8:11], a[76:79], v[192:195]
    ds_read_b128 a[96:99], v4 offset:49536
    s_waitcnt lgkmcnt(4)
    v_mfma_f32_16x16x32_bf16 v[196:199], a[8:11], a[80:83], v[196:199]
    ds_read_b128 a[100:103], v4 offset:50560
    s_waitcnt lgkmcnt(3)
    v_mfma_f32_16x16x32_bf16 v[180:183], a[12:15], a[84:87], v[180:183]
    v_mfma_f32_16x16x32_bf16 v[184:187], a[12:15], a[88:91], v[184:187]
    s_waitcnt lgkmcnt(1)
    v_mfma_f32_16x16x32_bf16 v[188:191], a[12:15], a[92:95], v[188:191]
    s_waitcnt vmcnt(0) lgkmcnt(0)
    s_barrier
    ds_read_b128 a[64:67], v5 offset:384
    ds_read_b128 a[68:71], v5 offset:5504
    v_mfma_f32_16x16x32_bf16 v[192:195], a[12:15], a[96:99], v[192:195]
    ds_read_b128 a[72:75], v5 offset:10624
    ds_read_b128 a[76:79], v5 offset:15744
    v_mfma_f32_16x16x32_bf16 v[196:199], a[12:15], a[100:103], v[196:199]
    s_waitcnt lgkmcnt(2)
    v_mfma_f32_16x16x32_bf16 v[180:183], a[16:19], a[64:67], v[180:183]
    ds_read_b128 a[84:87], v5 offset:1408
    v_mfma_f32_16x16x32_bf16 v[180:183], a[20:23], a[68:71], v[180:183]
    ds_read_b128 a[88:91], v5 offset:6528
    s_waitcnt lgkmcnt(2)
    v_mfma_f32_16x16x32_bf16 v[180:183], a[24:27], a[72:75], v[180:183]
    ds_read_b128 a[92:95], v5 offset:11648
    v_mfma_f32_16x16x32_bf16 v[180:183], a[28:31], a[76:79], v[180:183]
    ds_read_b128 a[96:99], v5 offset:16768
    s_waitcnt lgkmcnt(2)
    v_mfma_f32_16x16x32_bf16 v[184:187], a[16:19], a[84:87], v[184:187]
    ds_read_b128 a[64:67], v5 offset:2432
    v_mfma_f32_16x16x32_bf16 v[184:187], a[20:23], a[88:91], v[184:187]
    ds_read_b128 a[68:71], v5 offset:7552
    s_waitcnt lgkmcnt(2)
    v_mfma_f32_16x16x32_bf16 v[184:187], a[24:27], a[92:95], v[184:187]
    ds_read_b128 a[72:75], v5 offset:12672
    v_fma_f32 v200, v68, v180, v200
    v_fma_f32 v205, v69, v181, v205
    v_fma_f32 v210, v70, v182, v210
    v_fma_f32 v215, v71, v183, v215
    buffer_store_dword v200, v72, s[32:35], 0 offen offset:0
    buffer_store_dword v205, v72, s[32:35], 0 offen offset:2560
    buffer_store_dword v210, v73, s[32:35], 0 offen offset:0
    buffer_store_dword v215, v73, s[32:35], 0 offen offset:2560
    v_mfma_f32_16x16x32_bf16 v[184:187], a[28:31], a[96:99], v[184:187]
    ds_read_b128 a[76:79], v5 offset:17792
    s_waitcnt lgkmcnt(2)
    v_mfma_f32_16x16x32_bf16 v[188:191], a[16:19], a[64:67], v[188:191]
    ds_read_b128 a[84:87], v5 offset:3456
    v_mfma_f32_16x16x32_bf16 v[188:191], a[20:23], a[68:71], v[188:191]
    ds_read_b128 a[88:91], v5 offset:8576
    s_waitcnt lgkmcnt(2)
    v_mfma_f32_16x16x32_bf16 v[188:191], a[24:27], a[72:75], v[188:191]
    ds_read_b128 a[92:95], v5 offset:13696
    v_fma_f32 v201, v68, v184, v201
    v_fma_f32 v206, v69, v185, v206
    v_fma_f32 v211, v70, v186, v211
    v_fma_f32 v216, v71, v187, v216
    buffer_store_dword v201, v72, s[32:35], 0 offen offset:64
    buffer_store_dword v206, v72, s[32:35], 0 offen offset:2624
    buffer_store_dword v211, v73, s[32:35], 0 offen offset:64
    buffer_store_dword v216, v73, s[32:35], 0 offen offset:2624
    v_mfma_f32_16x16x32_bf16 v[188:191], a[28:31], a[76:79], v[188:191]
    ds_read_b128 a[96:99], v5 offset:18816
    s_waitcnt lgkmcnt(2)
    v_mfma_f32_16x16x32_bf16 v[192:195], a[16:19], a[84:87], v[192:195]
    ds_read_b128 a[64:67], v5 offset:4480
    v_mfma_f32_16x16x32_bf16 v[192:195], a[20:23], a[88:91], v[192:195]
    ds_read_b128 a[68:71], v5 offset:9600
    s_waitcnt lgkmcnt(2)
    v_mfma_f32_16x16x32_bf16 v[192:195], a[24:27], a[92:95], v[192:195]
    ds_read_b128 a[72:75], v5 offset:14720
    v_fma_f32 v202, v68, v188, v202
    v_fma_f32 v207, v69, v189, v207
    v_fma_f32 v212, v70, v190, v212
    v_fma_f32 v217, v71, v191, v217
    buffer_store_dword v202, v72, s[32:35], 0 offen offset:128
    buffer_store_dword v207, v72, s[32:35], 0 offen offset:2688
    buffer_store_dword v212, v73, s[32:35], 0 offen offset:128
    buffer_store_dword v217, v73, s[32:35], 0 offen offset:2688
    v_mfma_f32_16x16x32_bf16 v[192:195], a[28:31], a[96:99], v[192:195]
    ds_read_b128 a[76:79], v5 offset:19840
    s_waitcnt lgkmcnt(2)
    v_mfma_f32_16x16x32_bf16 v[196:199], a[16:19], a[64:67], v[196:199]
    v_mfma_f32_16x16x32_bf16 v[196:199], a[20:23], a[68:71], v[196:199]
    s_waitcnt lgkmcnt(0)
    v_mfma_f32_16x16x32_bf16 v[196:199], a[24:27], a[72:75], v[196:199]
    s_nop 3
    v_fma_f32 v203, v68, v192, v203
    v_fma_f32 v208, v69, v193, v208
    v_fma_f32 v213, v70, v194, v213
    v_fma_f32 v218, v71, v195, v218
    buffer_store_dword v203, v72, s[32:35], 0 offen offset:192
    buffer_store_dword v208, v72, s[32:35], 0 offen offset:2752
    buffer_store_dword v213, v73, s[32:35], 0 offen offset:192
    buffer_store_dword v218, v73, s[32:35], 0 offen offset:2752
    v_mfma_f32_16x16x32_bf16 v[196:199], a[28:31], a[76:79], v[196:199]
    s_nop 7
    v_fma_f32 v204, v68, v196, v204
    v_fma_f32 v209, v69, v197, v209
    v_fma_f32 v214, v70, v198, v214
    v_fma_f32 v219, v71, v199, v219
    buffer_store_dword v204, v72, s[32:35], 0 offen offset:256
    buffer_store_dword v209, v72, s[32:35], 0 offen offset:2816
    buffer_store_dword v214, v73, s[32:35], 0 offen offset:256
    buffer_store_dword v219, v73, s[32:35], 0 offen offset:2816
K_END:
    s_endpgm
.fill 16, 4, 0xBF800000
.p2align 8
.type LANETAB,@object
LANETAB:
.long 49152, 49184, 49216, 49248
.long 49280, 49312, 49344, 49376
.long 49424, 49456, 49488, 49520
.long 49552, 49584, 49616, 49648
.long 49696, 49664, 49760, 49728
.long 49824, 49792, 49888, 49856
.long 49968, 49936, 50032, 50000
.long 50096, 50064, 50160, 50128
.long 50240, 50272, 50176, 50208
.long 50368, 50400, 50304, 50336
.long 50512, 50544, 50448, 50480
.long 50640, 50672, 50576, 50608
.long 50784, 50752, 50720, 50688
.long 50912, 50880, 50848, 50816
.long 51056, 51024, 50992, 50960
.long 51184, 51152, 51120, 51088
.long 51200, 51232, 51264, 51296
.long 51328, 51360, 51392, 51424
.long 51472, 51504, 51536, 51568
.long 51600, 51632, 51664, 51696
.long 51744, 51712, 51808, 51776
.long 51872, 51840, 51936, 51904
.long 52016, 51984, 52080, 52048
.long 52144, 52112, 52208, 52176
.long 52288, 52320, 52224, 52256
.long 52416, 52448, 52352, 52384
.long 52560, 52592, 52496, 52528
.long 52688, 52720, 52624, 52656
.long 52832, 52800, 52768, 52736
.long 52960, 52928, 52896, 52864
.long 53104, 53072, 53040, 53008
.long 53232, 53200, 53168, 53136
.long 49168, 49200, 49232, 49264
.long 49296, 49328, 49360, 49392
.long 49408, 49440, 49472, 49504
.long 49536, 49568, 49600, 49632
.long 49712, 49680, 49776, 49744
.long 49840, 49808, 49904, 49872
.long 49952, 49920, 50016, 49984
.long 50080, 50048, 50144, 50112
.long 50256, 50288, 50192, 50224
.long 50384, 50416, 50320, 50352
.long 50496, 50528, 50432, 50464
.long 50624, 50656, 50560, 50592
.long 50800, 50768, 50736, 50704
.long 50928, 50896, 50864, 50832
.long 51040, 51008, 50976, 50944
.long 51168, 51136, 51104, 51072
.long 51216, 51248, 51280, 51312
.long 51344, 51376, 51408, 51440
.long 51456, 51488, 51520, 51552
.long 51584, 51616, 51648, 51680
.long 51760, 51728, 51824, 51792
.long 51888, 51856, 51952, 51920
.long 52000, 51968, 52064, 52032
.long 52128, 52096, 52192, 52160
.long 52304, 52336, 52240, 52272
.long 52432, 52464, 52368, 52400
.long 52544, 52576, 52480, 52512
.long 52672, 52704, 52608, 52640
.long 52848, 52816, 52784, 52752
.long 52976, 52944, 52912, 52880
.long 53088, 53056, 53024, 52992
.long 53216, 53184, 53152, 53120
.long 53248, 53280, 53312, 53344
.long 53376, 53408, 53440, 53472
.long 53520, 53552, 53584, 53616
.long 53648, 53680, 53712, 53744
.long 53792, 53760, 53856, 53824
.long 53920, 53888, 53984, 53952
.long 54064, 54032, 54128, 54096
.long 54192, 54160, 54256, 54224
.long 58432, 58464, 58368, 58400
.long 58560, 58592, 58496, 58528
.long 58704, 58736, 58640, 58672
.long 58832, 58864, 58768, 58800
.long 58976, 58944, 58912, 58880
.long 59104, 59072, 59040, 59008
.long 59248, 59216, 59184, 59152
.long 59376, 59344, 59312, 59280
.long 53248, 53280, 53312, 53344
.long 53376, 53408, 53440, 53472
.long 53520, 53552, 53584, 53616
.long 53648, 53680, 53712, 53744
.long 53792, 53760, 53856, 53824
.long 53920, 53888, 53984, 53952
.long 54064, 54032, 54128, 54096
.long 54192, 54160, 54256, 54224
.long 58432, 58464, 58368, 58400
.long 58560, 58592, 58496, 58528
.long 58704, 58736, 58640, 58672
.long 58832, 58864, 58768, 58800
.long 58976, 58944, 58912, 58880
.long 59104, 59072, 59040, 59008
.long 59248, 59216, 59184, 59152
.long 59376, 59344, 59312, 59280
.long 53264, 53296, 53328, 53360
.long 53392, 53424, 53456, 53488
.long 53504, 53536, 53568, 53600
.long 53632, 53664, 53696, 53728
.long 53808, 53776, 53872, 53840
.long 53936, 53904, 54000, 53968
.long 54048, 54016, 54112, 54080
.long 54176, 54144, 54240, 54208
.long 58448, 58480, 58384, 58416
.long 58576, 58608, 58512, 58544
.long 58688, 58720, 58624, 58656
.long 58816, 58848, 58752, 58784
.long 58992, 58960, 58928, 58896
.long 59120, 59088, 59056, 59024
.long 59232, 59200, 59168, 59136
.long 59360, 59328, 59296, 59264
.long 53264, 53296, 53328, 53360
.long 53392, 53424, 53456, 53488
.long 53504, 53536, 53568, 53600
.long 53632, 53664, 53696, 53728
.long 53808, 53776, 53872, 53840
.long 53936, 53904, 54000, 53968
.long 54048, 54016, 54112, 54080
.long 54176, 54144, 54240, 54208
.long 58448, 58480, 58384, 58416
.long 58576, 58608, 58512, 58544
.long 58688, 58720, 58624, 58656
.long 58816, 58848, 58752, 58784
.long 58992, 58960, 58928, 58896
.long 59120, 59088, 59056, 59024
.long 59232, 59200, 59168, 59136
.long 59360, 59328, 59296, 59264
.long 80256, 80320, 0, 49152
.long 80264, 80328, 8, 49160
.long 80272, 80336, 16, 49168
.long 80280, 80344, 24, 49176
.long 80384, 80448, 64, 49216
.long 80392, 80456, 72, 49224
.long 80400, 80464, 80, 49232
.long 80408, 80472, 88, 49240
.long 80576, 80512, 128, 49280
.long 80584, 80520, 136, 49288
.long 80592, 80528, 144, 49296
.long 80600, 80536, 152, 49304
.long 80704, 80640, 192, 49344
.long 80712, 80648, 200, 49352
.long 80720, 80656, 208, 49360
.long 80728, 80664, 216, 49368
.long 80288, 80352, 32, 49184
.long 80296, 80360, 40, 49192
.long 80304, 80368, 48, 49200
.long 80312, 80376, 56, 49208
.long 80416, 80480, 96, 49248
.long 80424, 80488, 104, 49256
.long 80432, 80496, 112, 49264
.long 80440, 80504, 120, 49272
.long 80608, 80544, 160, 49312
.long 80616, 80552, 168, 49320
.long 80624, 80560, 176, 49328
.long 80632, 80568, 184, 49336
.long 80736, 80672, 224, 49376
.long 80744, 80680, 232, 49384
.long 80752, 80688, 240, 49392
.long 80760, 80696, 248, 49400
.long 81280, 81344, 512, 49664
.long 81288, 81352, 520, 49672
.long 81296, 81360, 528, 49680
.long 81304, 81368, 536, 49688
.long 81408, 81472, 576, 49728
.long 81416, 81480, 584, 49736
.long 81424, 81488, 592, 49744
.long 81432, 81496, 600, 49752
.long 81600, 81536, 640, 49792
.long 81608, 81544, 648, 49800
.long 81616, 81552, 656, 49808
.long 81624, 81560, 664, 49816
.long 81728, 81664, 704, 49856
.long 81736, 81672, 712, 49864
.long 81744, 81680, 720, 49872
.long 81752, 81688, 728, 49880
.long 81312, 81376, 544, 49696
.long 81320, 81384, 552, 49704
.long 81328, 81392, 560, 49712
.long 81336, 81400, 568, 49720
.long 81440, 81504, 608, 49760
.long 81448, 81512, 616, 49768
.long 81456, 81520, 624, 49776
.long 81464, 81528, 632, 49784
.long 81632, 81568, 672, 49824
.long 81640, 81576, 680, 49832
.long 81648, 81584, 688, 49840
.long 81656, 81592, 696, 49848
.long 81760, 81696, 736, 49888
.long 81768, 81704, 744, 49896
.long 81776, 81712, 752, 49904
.long 81784, 81720, 760, 49912
.long 0, 23104, 25728, 0
.long 16, 23120, 25744, 0
.long 32, 23136, 26880, 0
.long 48, 23152, 26896, 0
.long 64, 23168, 26912, 0
.long 80, 23184, 26928, 0
.long 96, 24320, 26944, 0
.long 112, 24336, 26960, 0
.long 128, 24352, 26976, 0
.long 144, 24368, 26992, 0
.long 1280, 24384, 27008, 0
.long 1296, 24400, 27024, 0
.long 1312, 24416, 28160, 0
.long 1328, 24432, 28176, 0
.long 1344, 24448, 28192, 0
.long 1360, 24464, 28208, 0
.long 1376, 5120, 28224, 16
.long 1392, 5136, 28240, 16
.long 1408, 5152, 28256, 16
.long 1424, 5168, 28272, 16
.long 2560, 5184, 28288, 16
.long 2576, 5200, 28304, 16
.long 2592, 5216, 29440, 16
.long 2608, 5232, 29456, 16
.long 2624, 5248, 29472, 16
.long 2640, 5264, 29488, 16
.long 2656, 6400, 29504, 16
.long 2672, 6416, 29520, 16
.long 2688, 6432, 29536, 16
.long 2704, 6448, 29552, 16
.long 3840, 6464, 29568, 16
.long 3856, 6480, 29584, 16
.long 3872, 6496, 0, 4
.long 3888, 6512, 16, 4
.long 3904, 6528, 32, 4
.long 3920, 6544, 48, 4
.long 3936, 7680, 64, 4
.long 3952, 7696, 80, 4
.long 3968, 7712, 96, 4
.long 3984, 7728, 112, 4
.long 20480, 7744, 128, 4
.long 20496, 7760, 144, 4
.long 20512, 7776, 1280, 4
.long 20528, 7792, 1296, 4
.long 20544, 7808, 1312, 4
.long 20560, 7824, 1328, 4
.long 20576, 8960, 1344, 4
.long 20592, 8976, 1360, 4
.long 20608, 8992, 1376, 20
.long 20624, 9008, 1392, 20
.long 21760, 9024, 1408, 20
.long 21776, 9040, 1424, 20
.long 21792, 9056, 2560, 20
.long 21808, 9072, 2576, 20
.long 21824, 9088, 2592, 20
.long 21840, 9104, 2608, 20
.long 21856, 25600, 2624, 20
.long 21872, 25616, 2640, 20
.long 21888, 25632, 2656, 20
.long 21904, 25648, 2672, 20
.long 23040, 25664, 2688, 20
.long 23056, 25680, 2704, 20
.long 23072, 25696, 3840, 20
.long 23088, 25712, 3856, 20
.long 0, 0, 0, 0
.long 1, 8, 2, 0
.long 2, 16, 4, 0
.long 3, 24, 6, 0
.long 4, 160, 8, 0
.long 5, 168, 10, 0
.long 6, 176, 12, 0
.long 7, 184, 14, 0
.long 8, 320, 16, 0
.long 9, 328, 18, 0
.long 10, 336, 20, 0
.long 11, 344, 22, 0
.long 12, 480, 24, 0
.long 13, 488, 26, 0
.long 14, 496, 28, 0
.long 15, 504, 30, 0
.long 0, 640, 0, 0
.long 1, 648, 2, 0
.long 2, 656, 4, 0
.long 3, 664, 6, 0
.long 4, 800, 8, 0
.long 5, 808, 10, 0
.long 6, 816, 12, 0
.long 7, 824, 14, 0
.long 8, 960, 16, 0
.long 9, 968, 18, 0
.long 10, 976, 20, 0
.long 11, 984, 22, 0
.long 12, 1120, 24, 0
.long 13, 1128, 26, 0
.long 14, 1136, 28, 0
.long 15, 1144, 30, 0
.long 0, 1280, 0, 0
.long 1, 1288, 2, 0
.long 2, 1296, 4, 0
.long 3, 1304, 6, 0
.long 4, 1440, 8, 0
.long 5, 1448, 10, 0
.long 6, 1456, 12, 0
.long 7, 1464, 14, 0
.long 8, 1600, 16, 0
.long 9, 1608, 18, 0
.long 10, 1616, 20, 0
.long 11, 1624, 22, 0
.long 12, 1760, 24, 0
.long 13, 1768, 26, 0
.long 14, 1776, 28, 0
.long 15, 1784, 30, 0
.long 0, 1920, 0, 0
.long 1, 1928, 2, 0
.long 2, 1936, 4, 0
.long 3, 1944, 6, 0
.long 4, 2080, 8, 0
.long 5, 2088, 10, 0
.long 6, 2096, 12, 0
.long 7, 2104, 14, 0
.long 8, 2240, 16, 0
.long 9, 2248, 18, 0
.long 10, 2256, 20, 0
.long 11, 2264, 22, 0
.long 12, 2400, 24, 0
.long 13, 2408, 26, 0
.long 14, 2416, 28, 0
.long 15, 2424, 30, 0
.long 0, 0, 0, 0
.long 72, 32, 32, 16
.long 144, 8, 8, 32
.long 216, 40, 40, 48
.long 288, 72, 72, 64
.long 360, 104, 104, 80
.long 432, 80, 80, 96
.long 504, 112, 112, 112
.long 576, 144, 144, 128
.long 648, 176, 176, 144
.long 720, 152, 152, 160
.long 792, 184, 184, 176
.long 864, 216, 216, 192
.long 936, 248, 248, 208
.long 1008, 224, 224, 224
.long 1080, 256, 256, 240
.long 1152, 16, 16, 90112
.long 1224, 48, 48, 90128
.long 1296, 24, 24, 90144
.long 1368, 56, 56, 90160
.long 1440, 88, 88, 90176
.long 1512, 120, 120, 90192
.long 1584, 96, 96, 90208
.long 1656, 128, 128, 90224
.long 1728, 160, 160, 90240
.long 1800, 192, 192, 90256
.long 1872, 168, 168, 90272
.long 1944, 200, 200, 90288
.long 2016, 232, 232, 90304
.long 2088, 264, 264, 90320
.long 2160, 240, 240, 90336
.long 2232, 272, 272, 90352
.long 32, 2304, 576, 1024
.long 104, 2336, 608, 1040
.long 176, 2312, 584, 1056
.long 248, 2344, 616, 1072
.long 320, 2376, 648, 1088
.long 392, 2408, 680, 1104
.long 464, 2384, 656, 1120
.long 536, 2416, 688, 1136
.long 608, 2448, 720, 1152
.long 680, 2480, 752, 1168
.long 752, 2456, 728, 1184
.long 824, 2488, 760, 1200
.long 896, 2520, 792, 1216
.long 968, 2552, 824, 1232
.long 1040, 2528, 800, 1248
.long 1112, 2560, 832, 1264
.long 1184, 2320, 592, 91136
.long 1256, 2352, 624, 91152
.long 1328, 2328, 600, 91168
.long 1400, 2360, 632, 91184
.long 1472, 2392, 664, 91200
.long 1544, 2424, 696, 91216
.long 1616, 2400, 672, 91232
.long 1688, 2432, 704, 91248
.long 1760, 2464, 736, 91264
.long 1832, 2496, 768, 91280
.long 1904, 2472, 744, 91296
.long 1976, 2504, 776, 91312
.long 2048, 2536, 808, 91328
.long 2120, 2568, 840, 91344
.long 2192, 2544, 816, 91360
.long 2264, 2576, 848, 91376
.long 0, 256, 256, 0
.long 8, 264, 264, 16
.long 16, 272, 272, 32
.long 24, 280, 280, 48
.long 32, 288, 288, 64
.long 40, 296, 296, 80
.long 48, 304, 304, 96
.long 56, 312, 312, 112
.long 64, 256, 260, 128
.long 72, 264, 268, 144
.long 80, 272, 276, 160
.long 88, 280, 284, 176
.long 96, 288, 292, 192
.long 104, 296, 300, 208
.long 112, 304, 308, 224
.long 120, 312, 316, 240
.long 128, 256, 256, 256
.long 136, 264, 264, 272
.long 144, 272, 272, 288
.long 152, 280, 280, 304
.long 160, 288, 288, 320
.long 168, 296, 296, 336
.long 176, 304, 304, 352
.long 184, 312, 312, 368
.long 192, 256, 260, 384
.long 200, 264, 268, 400
.long 208, 272, 276, 416
.long 216, 280, 284, 432
.long 224, 288, 292, 448
.long 232, 296, 300, 464
.long 240, 304, 308, 480
.long 248, 312, 316, 496
.long 512, 768, 768, 0
.long 520, 776, 776, 16
.long 528, 784, 784, 32
.long 536, 792, 792, 48
.long 544, 800, 800, 64
.long 552, 808, 808, 80
.long 560, 816, 816, 96
.long 568, 824, 824, 112
.long 576, 768, 772, 128
.long 584, 776, 780, 144
.long 592, 784, 788, 160
.long 600, 792, 796, 176
.long 608, 800, 804, 192
.long 616, 808, 812, 208
.long 624, 816, 820, 224
.long 632, 824, 828, 240
.long 640, 768, 768, 256
.long 648, 776, 776, 272
.long 656, 784, 784, 288
.long 664, 792, 792, 304
.long 672, 800, 800, 320
.long 680, 808, 808, 336
.long 688, 816, 816, 352
.long 696, 824, 824, 368
.long 704, 768, 772, 384
.long 712, 776, 780, 400
.long 720, 784, 788, 416
.long 728, 792, 796, 432
.long 736, 800, 804, 448
.long 744, 808, 812, 464
.long 752, 816, 820, 480
.long 760, 824, 828, 496
.long 0, 9216, 18432, 27648
.long 16, 9232, 18448, 27664
.long 32, 9248, 18464, 27680
.long 48, 9264, 18480, 27696
.long 64, 9280, 18496, 27712
.long 80, 9296, 18512, 27728
.long 96, 9312, 18528, 27744
.long 112, 9328, 18544, 27760
.long 1280, 10496, 19712, 28928
.long 1296, 10512, 19728, 28944
.long 1312, 10528, 19744, 28960
.long 1328, 10544, 19760, 28976
.long 1344, 10560, 19776, 28992
.long 1360, 10576, 19792, 29008
.long 1376, 10592, 19808, 29024
.long 1392, 10608, 19824, 29040
.long 2560, 11776, 20992, 30208
.long 2576, 11792, 21008, 30224
.long 2592, 11808, 21024, 30240
.long 2608, 11824, 21040, 30256
.long 2624, 11840, 21056, 30272
.long 2640, 11856, 21072, 30288
.long 2656, 11872, 21088, 30304
.long 2672, 11888, 21104, 30320
.long 3840, 13056, 22272, 31488
.long 3856, 13072, 22288, 31504
.long 3872, 13088, 22304, 31520
.long 3888, 13104, 22320, 31536
.long 3904, 13120, 22336, 31552
.long 3920, 13136, 22352, 31568
.long 3936, 13152, 22368, 31584
.long 3952, 13168, 22384, 31600
.long 5120, 14336, 23552, 32768
.long 5136, 14352, 23568, 32784
.long 5152, 14368, 23584, 32800
.long 5168, 14384, 23600, 32816
.long 5184, 14400, 23616, 32832
.long 5200, 14416, 23632, 32848
.long 5216, 14432, 23648, 32864
.long 5232, 14448, 23664, 32880
.long 6400, 15616, 24832, 34048
.long 6416, 15632, 24848, 34064
.long 6432, 15648, 24864, 34080
.long 6448, 15664, 24880, 34096
.long 6464, 15680, 24896, 34112
.long 6480, 15696, 24912, 34128
.long 6496, 15712, 24928, 34144
.long 6512, 15728, 24944, 34160
.long 7680, 16896, 26112, 35328
.long 7696, 16912, 26128, 35344
.long 7712, 16928, 26144, 35360
.long 7728, 16944, 26160, 35376
.long 7744, 16960, 26176, 35392
.long 7760, 16976, 26192, 35408
.long 7776, 16992, 26208, 35424
.long 7792, 17008, 26224, 35440
.long 8960, 18176, 27392, 36608
.long 8976, 18192, 27408, 36624
.long 8992, 18208, 27424, 36640
.long 9008, 18224, 27440, 36656
.long 9024, 18240, 27456, 36672
.long 9040, 18256, 27472, 36688
.long 9056, 18272, 27488, 36704
.long 9072, 18288, 27504, 36720
.long 0, 4160, 8320, 12480
.long 16, 4176, 8336, 12496
.long 32, 4192, 8352, 12512
.long 48, 4208, 8368, 12528
.long 64, 4096, 8384, 12416
.long 80, 4112, 8400, 12432
.long 96, 4128, 8416, 12448
.long 112, 4144, 8432, 12464
.long 128, 4288, 8192, 12352
.long 144, 4304, 8208, 12368
.long 160, 4320, 8224, 12384
.long 176, 4336, 8240, 12400
.long 192, 4224, 8256, 12288
.long 208, 4240, 8272, 12304
.long 224, 4256, 8288, 12320
.long 240, 4272, 8304, 12336
.long 1296, 5456, 9616, 13776
.long 1280, 5440, 9600, 13760
.long 1328, 5488, 9648, 13808
.long 1312, 5472, 9632, 13792
.long 1360, 5392, 9680, 13712
.long 1344, 5376, 9664, 13696
.long 1392, 5424, 9712, 13744
.long 1376, 5408, 9696, 13728
.long 1424, 5584, 9488, 13648
.long 1408, 5568, 9472, 13632
.long 1456, 5616, 9520, 13680
.long 1440, 5600, 9504, 13664
.long 1488, 5520, 9552, 13584
.long 1472, 5504, 9536, 13568
.long 1520, 5552, 9584, 13616
.long 1504, 5536, 9568, 13600
.long 2592, 6752, 10912, 15072
.long 2608, 6768, 10928, 15088
.long 2560, 6720, 10880, 15040
.long 2576, 6736, 10896, 15056
.long 2656, 6688, 10976, 15008
.long 2672, 6704, 10992, 15024
.long 2624, 6656, 10944, 14976
.long 2640, 6672, 10960, 14992
.long 2720, 6880, 10784, 14944
.long 2736, 6896, 10800, 14960
.long 2688, 6848, 10752, 14912
.long 2704, 6864, 10768, 14928
.long 2784, 6816, 10848, 14880
.long 2800, 6832, 10864, 14896
.long 2752, 6784, 10816, 14848
.long 2768, 6800, 10832, 14864
.long 3888, 8048, 12208, 16368
.long 3872, 8032, 12192, 16352
.long 3856, 8016, 12176, 16336
.long 3840, 8000, 12160, 16320
.long 3952, 7984, 12272, 16304
.long 3936, 7968, 12256, 16288
.long 3920, 7952, 12240, 16272
.long 3904, 7936, 12224, 16256
.long 4016, 8176, 12080, 16240
.long 4000, 8160, 12064, 16224
.long 3984, 8144, 12048, 16208
.long 3968, 8128, 12032, 16192
.long 4080, 8112, 12144, 16176
.long 4064, 8096, 12128, 16160
.long 4048, 8080, 12112, 16144
.long 4032, 8064, 12096, 16128
.long 0, 32, 64, 96
.long 8, 40, 72, 104
.long 16, 48, 80, 112
.long 24, 56, 88, 120
.long 128, 160, 192, 224
.long 136, 168, 200, 232
.long 144, 176, 208, 240
.long 152, 184, 216, 248
.long 256, 288, 320, 352
.long 264, 296, 328, 360
.long 272, 304, 336, 368
.long 280, 312, 344, 376
.long 384, 416, 448, 480
.long 392, 424, 456, 488
.long 400, 432, 464, 496
.long 408, 440, 472, 504
.long 512, 544, 576, 608
.long 520, 552, 584, 616
.long 528, 560, 592, 624
.long 536, 568, 600, 632
.long 640, 672, 704, 736
.long 648, 680, 712, 744
.long 656, 688, 720, 752
.long 664, 696, 728, 760
.long 768, 800, 832, 864
.long 776, 808, 840, 872
.long 784, 816, 848, 880
.long 792, 824, 856, 888
.long 896, 928, 960, 992
.long 904, 936, 968, 1000
.long 912, 944, 976, 1008
.long 920, 952, 984, 1016
.long 2048, 2080, 2112, 2144
.long 2056, 2088, 2120, 2152
.long 2064, 2096, 2128, 2160
.long 2072, 2104, 2136, 2168
.long 2176, 2208, 2240, 2272
.long 2184, 2216, 2248, 2280
.long 2192, 2224, 2256, 2288
.long 2200, 2232, 2264, 2296
.long 2304, 2336, 2368, 2400
.long 2312, 2344, 2376, 2408
.long 2320, 2352, 2384, 2416
.long 2328, 2360, 2392, 2424
.long 2432, 2464, 2496, 2528
.long 2440, 2472, 2504, 2536
.long 2448, 2480, 2512, 2544
.long 2456, 2488, 2520, 2552
.long 2560, 2592, 2624, 2656
.long 2568, 2600, 2632, 2664
.long 2576, 2608, 2640, 2672
.long 2584, 2616, 2648, 2680
.long 2688, 2720, 2752, 2784
.long 2696, 2728, 2760, 2792
.long 2704, 2736, 2768, 2800
.long 2712, 2744, 2776, 2808
.long 2816, 2848, 2880, 2912
.long 2824, 2856, 2888, 2920
.long 2832, 2864, 2896, 2928
.long 2840, 2872, 2904, 2936
.long 2944, 2976, 3008, 3040
.long 2952, 2984, 3016, 3048
.long 2960, 2992, 3024, 3056
.long 2968, 3000, 3032, 3064
.long 0, 64, 128, 192
.long 272, 336, 400, 464
.long 544, 608, 672, 736
.long 816, 880, 944, 1008
.long 1088, 1024, 1216, 1152
.long 1360, 1296, 1488, 1424
.long 1632, 1568, 1760, 1696
.long 1904, 1840, 2032, 1968
.long 2176, 2240, 2048, 2112
.long 2448, 2512, 2320, 2384
.long 2720, 2784, 2592, 2656
.long 2992, 3056, 2864, 2928
.long 3264, 3200, 3136, 3072
.long 3536, 3472, 3408, 3344
.long 3808, 3744, 3680, 3616
.long 4080, 4016, 3952, 3888
.long 16, 80, 144, 208
.long 256, 320, 384, 448
.long 560, 624, 688, 752
.long 800, 864, 928, 992
.long 1104, 1040, 1232, 1168
.long 1344, 1280, 1472, 1408
.long 1648, 1584, 1776, 1712
.long 1888, 1824, 2016, 1952
.long 2192, 2256, 2064, 2128
.long 2432, 2496, 2304, 2368
.long 2736, 2800, 2608, 2672
.long 2976, 3040, 2848, 2912
.long 3280, 3216, 3152, 3088
.long 3520, 3456, 3392, 3328
.long 3824, 3760, 3696, 3632
.long 4064, 4000, 3936, 3872
.long 32, 96, 160, 224
.long 304, 368, 432, 496
.long 512, 576, 640, 704
.long 784, 848, 912, 976
.long 1120, 1056, 1248, 1184
.long 1392, 1328, 1520, 1456
.long 1600, 1536, 1728, 1664
.long 1872, 1808, 2000, 1936
.long 2208, 2272, 2080, 2144
.long 2480, 2544, 2352, 2416
.long 2688, 2752, 2560, 2624
.long 2960, 3024, 2832, 2896
.long 3296, 3232, 3168, 3104
.long 3568, 3504, 3440, 3376
.long 3776, 3712, 3648, 3584
.long 4048, 3984, 3920, 3856
.long 48, 112, 176, 240
.long 288, 352, 416, 480
.long 528, 592, 656, 720
.long 768, 832, 896, 960
.long 1136, 1072, 1264, 1200
.long 1376, 1312, 1504, 1440
.long 1616, 1552, 1744, 1680
.long 1856, 1792, 1984, 1920
.long 2224, 2288, 2096, 2160
.long 2464, 2528, 2336, 2400
.long 2704, 2768, 2576, 2640
.long 2944, 3008, 2816, 2880
.long 3312, 3248, 3184, 3120
.long 3552, 3488, 3424, 3360
.long 3792, 3728, 3664, 3600
.long 4032, 3968, 3904, 3840
.size LANETAB, .-LANETAB
CODE_END:
.fill 64, 4, 0
.section .rodata,"a"
.p2align 6
.amdhsa_kernel gated_mix__ssm_conv_s5__glu_gated_bilinear__prompt_kernel
  .amdhsa_next_free_vgpr 512
  .amdhsa_next_free_sgpr 102
  .amdhsa_accum_offset 256
  .amdhsa_group_segment_fixed_size 0
  .amdhsa_kernarg_size 136
  .amdhsa_user_sgpr_count 2
  .amdhsa_user_sgpr_kernarg_segment_ptr 1
  .amdhsa_system_sgpr_workgroup_id_x 1
.end_amdhsa_kernel
```
